```python
import torch

def _softmax(x, axis=-1):
    return torch.softmax(x, dim=axis)
def _gelu(x):
    return torch.nn.functional.gelu(x, approximate="tanh")
def _silu(x):
    return torch.nn.functional.silu(x)
def _sigmoid(x):
    return torch.sigmoid(x)
def _layernorm(x, axis=-1, eps=1e-5):
    m = x.mean(dim=axis, keepdim=True)
    v = x.var(dim=axis, keepdim=True, unbiased=False)
    return (x - m) / torch.sqrt(v + eps)
def _scatter_add(tgt, idx, src, axis=0):
    return tgt.clone().index_add_(axis, idx, src)
def _segment_sum(src, seg, n):
    out = torch.zeros((n,) + src.shape[1:], dtype=src.dtype)
    return out.index_add_(0, seg, src)
def _pad(x, pw):
    flat = tuple(v for pair in reversed(pw) for v in pair)
    return torch.nn.functional.pad(x, flat)

kernel_name = 'parallel_sum__sliding_block_cached__swiglu_ffn__decode'

def setup_inputs():

    _w = (lambda a: (lambda t: t.to(torch.bfloat16) if t.is_floating_point() else t)(torch.as_tensor(a)))
    def _A_setup():
        B, Sq, D = 1, 1, 512
        Hq, Hkv, Sk, Dh = 32, 8, 65536, 128
        assert Hq % Hkv == 0, (Hq, Hkv)
        return {
            "x": _w((lambda *s: torch.randn(*s, dtype=torch.bfloat16) * 0.05)(B, Sq, D)),
            "k_cache": _w((lambda *s: torch.randn(*s, dtype=torch.bfloat16) * 3.2)(B, Hkv, Sk, Dh)),
            "v_cache": _w((lambda *s: torch.randn(*s, dtype=torch.bfloat16) * 1.6)(B, Hkv, Sk, Dh)),
            "wq": _w((lambda *s: torch.randn(*s, dtype=torch.bfloat16) * 3.2)(D, Hq * Dh) * (D ** -0.5)),
            "wo": _w((lambda *s: torch.randn(*s, dtype=torch.bfloat16) * 1.6)(Hq * Dh, D) * ((Hq * Dh) ** -0.5)),
        }
    _A_in = _A_setup()

    def _B_setup():
        B, S, D, F = 1, 1, 512, 1792
        return {
            "x": _w((lambda *s: torch.randn(*s, dtype=torch.bfloat16) * 0.05)(B, S, D)),
            "w_gate": _w((lambda *s: torch.randn(*s, dtype=torch.bfloat16) * 0.05)(D, F)),
            "w_up": _w((lambda *s: torch.randn(*s, dtype=torch.bfloat16) * 0.05)(D, F)),
            "w_down": _w((lambda *s: torch.randn(*s, dtype=torch.bfloat16) * 0.05)(F, D)),
        }
    _B_in = _B_setup()

    return {
        "A_x": _A_in["x"],
        "A_k_cache": _A_in["k_cache"],
        "A_v_cache": _A_in["v_cache"],
        "A_wq": _A_in["wq"],
        "A_wo": _A_in["wo"],
        "B_x": _B_in["x"],
        "B_w_gate": _B_in["w_gate"],
        "B_w_up": _B_in["w_up"],
        "B_w_down": _B_in["w_down"],
    }

def reference(A_x, A_k_cache, A_v_cache, A_wq, A_wo, B_x, B_w_gate, B_w_up, B_w_down):
    def _A_ref(x, k_cache, v_cache, wq, wo):
        B, Sq, D = x.shape
        Hq, Dh = 32, 128
        Hkv, Sk = k_cache.shape[1], k_cache.shape[2]
        W = min(4096, max(256, Sk // 4))
        rep = Hq // Hkv
        q = (lambda x, *d: x.permute(*d))((x @ wq).reshape(B, Sq, Hq, Dh), 0, 2, 1, 3)
        k = (lambda x, n, axis: torch.repeat_interleave(x, n, dim=axis))(k_cache[:, :, Sk - W:, :], rep, axis=1)
        v = (lambda x, n, axis: torch.repeat_interleave(x, n, dim=axis))(v_cache[:, :, Sk - W:, :], rep, axis=1)
        scores = torch.einsum("bhqd,bhkd->bhqk", q, k) * (Dh ** -0.5)
        p = _softmax(scores, axis=-1)
        o = torch.einsum("bhqk,bhkd->bhqd", p, v)
        return (lambda x, *d: x.permute(*d))(o, 0, 2, 1, 3).reshape(B, Sq, Hq * Dh) @ wo

    def _B_ref(x, w_gate, w_up, w_down):
        g = _silu(x @ w_gate)
        u = x @ w_up
        return (g * u) @ w_down

    x = A_x
    xn = _layernorm(x, axis=-1)
    return x + _A_ref(xn, A_k_cache, A_v_cache, A_wq, A_wo) + _B_ref(xn, B_w_gate, B_w_up, B_w_down)
```

```asm
; @launch grid=(256,1,1) block=(384,1,1) lds=129120
.amdgcn_target "amdgcn-amd-amdhsa--gfx950"
.text
.globl parallel_sum__sliding_block_cached__swiglu_ffn__decode_kernel
.p2align 8
.type parallel_sum__sliding_block_cached__swiglu_ffn__decode_kernel,@function
parallel_sum__sliding_block_cached__swiglu_ffn__decode_kernel:
  s_cmpk_ge_u32 s2, 256
  s_cbranch_scc1 L_end
  s_load_dwordx16 s[8:23], s[0:1], 0
  s_load_dwordx8 s[24:31], s[0:1], 64
  v_readfirstlane_b32 s3, v0
  s_and_b32 s4, s2, 7
  s_lshr_b32 s5, s2, 3
  s_and_b32 s6, s5, 7
  s_lshr_b32 s7, s5, 3
  s_cmp_ge_u32 s3, 64
  s_cbranch_scc1 L_oth
L_loader:
  s_getpc_b64 s[36:37]
L_pc:
  v_lshlrev_b32 v3, 7, v0
  global_load_dword v30, v3, s[36:37]
  v_add_u32 v3, 0x2000, v3
  v_min_u32 v3, L_end-L_pc, v3
  global_load_dword v30, v3, s[36:37]
  v_lshlrev_b32 v2, 4, v0
  v_lshrrev_b32 v6, 3, v0
  v_and_b32 v7, 7, v0
  v_lshlrev_b32 v15, 17, v6
  v_lshl_add_u32 v15, v7, 4, v15
  s_lshl_b32 s35, s7, 13
  s_lshl3_add_u32 s35, s4, s35
  s_add_u32 s35, s35, s6
  s_lshl_b32 s39, s35, 7
  s_mov_b32 s47, 0x20000
  s_lshl_b32 s46, 1, 22
  s_bfm_b32 s34, 16, 0
  s_movk_i32 s54, 0x400
  s_mov_b32 s55, s47
  s_mov_b32 m0, 122880
  s_setprio 3
  s_add_u32 s38, s39, s47
  s_waitcnt lgkmcnt(0)
  s_mov_b32 s52, s8
  s_and_b32 s53, s9, s34
  buffer_load_dwordx4 v2, s[52:55], 0 offen  lds
  s_addk_i32 m0, -16384
  s_mov_b32 s44, s14
  s_and_b32 s45, s15, s34
L_ql:
  buffer_load_dwordx4 v15, s[44:47], s39 offen nt lds
  s_addk_i32 m0, 0x400
  s_addk_i32 s39, 0x2000
  buffer_load_dwordx4 v15, s[44:47], s39 offen nt lds
  s_addk_i32 m0, 0x400
  s_addk_i32 s39, 0x2000
  buffer_load_dwordx4 v15, s[44:47], s39 offen nt lds
  s_addk_i32 m0, 0x400
  s_addk_i32 s39, 0x2000
  buffer_load_dwordx4 v15, s[44:47], s39 offen nt lds
  s_addk_i32 m0, 0x400
  s_addk_i32 s39, 0x2000
  s_cmp_lt_u32 s39, s38
  s_cbranch_scc1 L_ql
  s_lshr_b32 s59, s4, 1
  s_bitcmp0_b32 s4, 0
  s_cselect_b32 s33, 4, 0
  s_add_u32 s59, s59, s33
  s_lshl3_add_u32 s33, s7, s59
  v_mov_b32 v1, 129024
  s_cmp_eq_u32 s6, 3
  s_cselect_b64 vcc, -1, 0
  s_and_b32 s35, s2, 7
  s_bitcmp1_b32 85, s35
  s_cselect_b64 vcc, -1, vcc
  v_and_b32 v2, 15, v0
  v_lshrrev_b32 v3, 4, v0
  v_xor_b32 v4, v2, v3
  v_lshlrev_b32 v4, 4, v4
  v_lshlrev_b32 v5, 8, v3
  v_xor_b32 v8, 0, v4
  v_add_u32 v8, v8, v5
  v_xor_b32 v9, 64, v4
  v_add_u32 v9, v9, v5
  v_xor_b32 v10, 128, v4
  v_add_u32 v10, v10, v5
  v_xor_b32 v11, 192, v4
  v_add_u32 v11, v11, v5
  s_lshl_b32 s35, s4, 24
  s_lshl_b32 s36, s5, 15
  s_add_u32 s35, s35, s36
  s_add_u32 s35, s35, 15728640
  s_lshl_b32 s40, s4, 12
  s_add_u32 s44, s10, s35
  s_addc_u32 s45, s11, 0
  s_and_b32 s45, s45, 0xffff
  s_mov_b32 s46, 32768
  s_add_u32 s12, s12, s35
  s_addc_u32 s13, s13, 0
  s_mov_b32 m0, 0
  s_nop 0
  buffer_load_dwordx4 v8, s[44:47], s40 offen offset:0 nt lds
  buffer_load_dwordx4 v8, s[44:47], s40 offen offset:1024 nt lds
  buffer_load_dwordx4 v9, s[44:47], s40 offen offset:2048 nt lds
  s_barrier
  s_waitcnt vmcnt(19)
  v_mov_b32 v20, 1
  ds_write_b32 v1, v20 offset:0
L_split:
  s_branch L_ld2
  .p2align 6
L_oth:
  s_lshr_b32 s3, s3, 6
  v_and_b32 v0, 63, v0
  s_lshr_b32 s59, s4, 1
  s_bitcmp0_b32 s4, 0
  s_cselect_b32 s33, 4, 0
  s_add_u32 s59, s59, s33
  s_lshl3_add_u32 s33, s7, s59
  v_mov_b32 v1, 129024
  s_cmp_eq_u32 s3, 1
  s_cbranch_scc1 L_aw
  v_mov_b32 v4, 0
  v_lshl_add_u32 v5, v0, 2, v1
  s_mov_b64 exec, 0xfffff
  ds_write_b32 v5, v4
  s_mov_b64 exec, -1
  s_waitcnt lgkmcnt(0)
  s_cmp_lt_u32 s7, 1
  s_cselect_b32 s35, s3, 0
  s_cmp_eq_u32 s35, 5
  s_cbranch_scc0 L_nprb
  s_load_dword s32, s[30:31], 0
  s_and_b32 s35, s6, 1
  s_andn2_b32 s36, s2, 63
  s_add_u32 s36, s36, s2
  s_lshl_b32 s36, s36, 7
  s_mov_b32 s48, s30
  s_and_b32 s49, s31, 0xffff
  s_mov_b32 s50, 1605632
  s_mov_b32 s51, 0x20000
  s_lshl_b32 s37, s35, 13
  s_add_u32 s36, s36, s37
  s_add_u32 s36, s36, 1343488
  s_xor_b32 s37, s36, 0x2000
  s_mov_b64 exec, 1
  buffer_load_dword v176, off, s[48:51], s36 nt
  buffer_load_dword v177, off, s[48:51], s37 nt
  s_getreg_b32 s37, hwreg(HW_REG_XCC_ID, 2, 1)
  s_xnor_b32 s35, s35, s37
  s_and_b32 s35, s35, 1
  s_lshl3_add_u32 s38, s33, s6
  s_lshl_b32 s38, s38, 2
  s_barrier
  s_waitcnt vmcnt(1)
  s_getreg_b32 s36, hwreg(HW_REG_IB_STS, 0, 4)
  s_lshl_b32 s36, s36, s35
  s_waitcnt lgkmcnt(0)
  s_add_u32 s32, s32, 0x9e3779b9
  s_xor_b32 s36, s36, s32
  v_mov_b32 v22, s36
  buffer_store_dword v22, off, s[48:51], s38 offset:2048 sc1
  s_mov_b64 exec, -1
  s_branch L_prd
L_nprb:
  s_barrier
L_prd:
  s_mov_b32 s40, 65536
spin_1:
  s_sleep 4
  ds_read_b32 v20, v1 offset:0
  s_sub_u32 s40, s40, 1
  s_cbranch_scc1 L_end
  s_waitcnt lgkmcnt(0)
  v_cmp_gt_u32 vcc, 2, v20
  s_cbranch_vccnz spin_1
  s_branch L_comp
L_aw:
  v_lshlrev_b32 v2, 4, v0
  s_waitcnt lgkmcnt(0)
  s_load_dword s32, s[30:31], 0
  s_barrier
L_aux:
  s_mov_b32 s48, s30
  s_and_b32 s49, s31, 0xffff
  s_mov_b32 s50, 1605632
  s_mov_b32 s51, 0x20000
  v_lshrrev_b32 v3, 3, v0
  v_and_b32 v4, 7, v0
  v_and_b32 v6, 1, v0
  v_lshlrev_b32 v6, 4, v6
  v_mov_b32 v7, 0xffff
  v_lshlrev_b32 v6, v6, v7
  v_bfe_u32 v7, v0, 1, 2
  v_cmp_eq_u32 vcc, 0, v7
  s_nop 1
  v_cndmask_b32 v12, 0, v6, vcc
  v_cmp_eq_u32 vcc, 1, v7
  s_nop 1
  v_cndmask_b32 v13, 0, v6, vcc
  v_cmp_eq_u32 vcc, 2, v7
  s_nop 1
  v_cndmask_b32 v14, 0, v6, vcc
  v_cmp_eq_u32 vcc, 3, v7
  s_nop 1
  v_cndmask_b32 v15, 0, v6, vcc
  v_lshlrev_b32 v6, 5, v0
  v_add_u32 v6, 123904, v6
  s_lshl_b32 s35, s7, 9
  s_add_u32 s35, s35, 123904
  v_lshl_add_u32 v7, v3, 6, s35
  v_add_u32 v25, 122880, v2
  s_mov_b32 s40, 65536
spin_103:
  ds_read_b32 v24, v1 offset:0
  ds_read_b128 v[8:11], v25
  s_sub_u32 s40, s40, 1
  s_cbranch_scc1 L_end
  s_waitcnt lgkmcnt(0)
  v_cmp_gt_u32 vcc, 1, v24
  s_cbranch_vccnz spin_103
  v_lshlrev_b32 v16, 16, v8
  v_and_b32 v17, 0xffff0000, v8
  v_lshlrev_b32 v18, 16, v9
  v_and_b32 v19, 0xffff0000, v9
  v_lshlrev_b32 v20, 16, v10
  v_and_b32 v21, 0xffff0000, v10
  v_lshlrev_b32 v22, 16, v11
  v_and_b32 v23, 0xffff0000, v11
  v_add_f32 v24, v16, v17
  v_add_f32 v25, v18, v19
  v_add_f32 v26, v20, v21
  v_add_f32 v27, v22, v23
  v_add_f32 v24, v24, v25
  v_add_f32 v26, v26, v27
  v_add_f32 v24, v24, v26
  s_nop 1
  v_add_f32_dpp v24, v24, v24 row_ror:8 row_mask:0xf bank_mask:0xf
  s_nop 1
  v_add_f32_dpp v24, v24, v24 row_ror:4 row_mask:0xf bank_mask:0xf
  s_nop 1
  v_add_f32_dpp v24, v24, v24 row_ror:2 row_mask:0xf bank_mask:0xf
  s_nop 1
  v_add_f32_dpp v24, v24, v24 row_ror:1 row_mask:0xf bank_mask:0xf
  v_mov_b32 v25, v24
  s_nop 1
  v_permlane16_swap_b32 v24, v25
  v_add_f32 v24, v24, v25
  v_mov_b32 v25, v24
  s_nop 1
  v_permlane32_swap_b32 v24, v25
  v_add_f32 v24, v24, v25
  v_mul_f32 v24, 0x3b000000, v24
  v_sub_f32 v32, v16, v24
  v_sub_f32 v33, v17, v24
  v_sub_f32 v34, v18, v24
  v_sub_f32 v35, v19, v24
  v_sub_f32 v36, v20, v24
  v_sub_f32 v37, v21, v24
  v_sub_f32 v38, v22, v24
  v_sub_f32 v39, v23, v24
  v_mul_f32 v26, v32, v32
  v_mul_f32 v27, v33, v33
  v_fmac_f32 v26, v34, v34
  v_fmac_f32 v27, v35, v35
  v_fmac_f32 v26, v36, v36
  v_fmac_f32 v27, v37, v37
  v_fmac_f32 v26, v38, v38
  v_fmac_f32 v27, v39, v39
  v_add_f32 v26, v26, v27
  v_cvt_pk_bf16_f32 v24, 0, v24
  s_nop 0
  v_add_f32_dpp v26, v26, v26 row_ror:8 row_mask:0xf bank_mask:0xf
  s_nop 1
  v_add_f32_dpp v26, v26, v26 row_ror:4 row_mask:0xf bank_mask:0xf
  s_nop 1
  v_add_f32_dpp v26, v26, v26 row_ror:2 row_mask:0xf bank_mask:0xf
  s_nop 1
  v_add_f32_dpp v26, v26, v26 row_ror:1 row_mask:0xf bank_mask:0xf
  v_mov_b32 v25, v26
  s_nop 1
  v_permlane16_swap_b32 v26, v25
  v_add_f32 v26, v26, v25
  v_mov_b32 v25, v26
  s_nop 1
  v_permlane32_swap_b32 v26, v25
  v_add_f32 v26, v26, v25
  v_sub_f32 v16, v16, v24
  v_sub_f32 v17, v17, v24
  v_sub_f32 v18, v18, v24
  v_sub_f32 v19, v19, v24
  v_sub_f32 v20, v20, v24
  v_sub_f32 v21, v21, v24
  v_sub_f32 v22, v22, v24
  v_sub_f32 v23, v23, v24
  v_mul_f32 v26, 0x3b000000, v26
  v_cvt_pk_bf16_f32 v26, 0, v26
  v_add_f32 v26, 0x3727c5ac, v26
  v_cvt_pk_bf16_f32 v26, 0, v26
  v_sqrt_f32 v26, v26
  v_cvt_pk_bf16_f32 v16, 0, v16
  v_cvt_pk_bf16_f32 v17, 0, v17
  v_cvt_pk_bf16_f32 v18, 0, v18
  v_cvt_pk_bf16_f32 v19, 0, v19
  v_cvt_pk_bf16_f32 v20, 0, v20
  v_cvt_pk_bf16_f32 v21, 0, v21
  v_cvt_pk_bf16_f32 v22, 0, v22
  v_cvt_pk_bf16_f32 v23, 0, v23
  v_cvt_pk_bf16_f32 v26, 0, v26
  v_rcp_f32 v27, v26
  s_nop 0
  v_mul_f32 v32, v16, v27
  v_mul_f32 v33, v17, v27
  v_mul_f32 v34, v18, v27
  v_mul_f32 v35, v19, v27
  v_mul_f32 v36, v20, v27
  v_mul_f32 v37, v21, v27
  v_mul_f32 v38, v22, v27
  v_mul_f32 v39, v23, v27
  v_fma_f32 v16, -v32, v26, v16
  v_fma_f32 v17, -v33, v26, v17
  v_fma_f32 v18, -v34, v26, v18
  v_fma_f32 v19, -v35, v26, v19
  v_fma_f32 v20, -v36, v26, v20
  v_fma_f32 v21, -v37, v26, v21
  v_fma_f32 v22, -v38, v26, v22
  v_fma_f32 v23, -v39, v26, v23
  v_fmac_f32 v32, v16, v27
  v_fmac_f32 v33, v17, v27
  v_fmac_f32 v34, v18, v27
  v_fmac_f32 v35, v19, v27
  v_fmac_f32 v36, v20, v27
  v_fmac_f32 v37, v21, v27
  v_fmac_f32 v38, v22, v27
  v_fmac_f32 v39, v23, v27
  v_cvt_pk_bf16_f32 v32, v32, v32
  v_cvt_pk_bf16_f32 v33, v33, v33
  v_cvt_pk_bf16_f32 v34, v34, v34
  v_cvt_pk_bf16_f32 v35, v35, v35
  v_cvt_pk_bf16_f32 v36, v36, v36
  v_cvt_pk_bf16_f32 v37, v37, v37
  v_cvt_pk_bf16_f32 v38, v38, v38
  v_cvt_pk_bf16_f32 v39, v39, v39
  ds_write_b128 v6, v[32:35]
  ds_write_b128 v6, v[36:39] offset:16
  ds_read_b128 v[16:19], v7 offset:0
  ds_read_b128 v[20:23], v7 offset:16
  ds_read_b128 v[24:27], v7 offset:32
  ds_read_b128 v[28:31], v7 offset:48
  v_lshlrev_b32 v5, 5, v4
  v_bfe_u32 v6, v0, 4, 1
  v_lshl_add_u32 v5, v6, 4, v5
  v_mov_b32 v61, v5
  v_lshrrev_b32 v6, 5, v0
  v_lshl_add_u32 v5, v6, 3, v5
  s_lshl_b32 s35, s4, 5
  s_lshl_b32 s36, s6, 2
  s_add_u32 s35, s35, s36
  s_add_u32 s35, s35, s7
  s_lshl_b32 s35, s35, 8
  s_add_u32 s35, s35, 4096
  v_add_u32 v9, s35, v61
  v_mov_b32 v56, 0xff
  s_mov_b32 s43, 65536
  s_waitcnt lgkmcnt(0)
  s_add_u32 s32, s32, 0x9e3779b9
  s_getreg_b32 s42, hwreg(HW_REG_XCC_ID, 0, 4)
  s_add_u32 s42, s42, 1
  s_mul_i32 s42, s42, 0x01010101
  s_xor_b32 s42, s42, s32
  v_mov_b32 v57, s42
  v_lshrrev_b32 v58, 8, v57
  v_lshrrev_b32 v59, 16, v57
  v_lshrrev_b32 v60, 24, v57
  v_add_u32 v11, 106496, v2
  v_and_b32 v128, v16, v12
  v_and_b32 v129, v16, v13
  v_and_b32 v130, v16, v14
  v_and_b32 v131, v16, v15
  v_and_b32 v132, v17, v12
  v_and_b32 v133, v17, v13
  v_and_b32 v134, v17, v14
  v_and_b32 v135, v17, v15
  v_and_b32 v136, v18, v12
  v_and_b32 v137, v18, v13
  v_and_b32 v138, v18, v14
  v_and_b32 v139, v18, v15
  v_and_b32 v140, v19, v12
  v_and_b32 v141, v19, v13
  v_and_b32 v142, v19, v14
  v_and_b32 v143, v19, v15
  v_and_b32 v144, v20, v12
  v_and_b32 v145, v20, v13
  v_and_b32 v146, v20, v14
  v_and_b32 v147, v20, v15
  v_and_b32 v148, v21, v12
  v_and_b32 v149, v21, v13
  v_and_b32 v150, v21, v14
  v_and_b32 v151, v21, v15
  v_and_b32 v152, v22, v12
  v_and_b32 v153, v22, v13
  v_and_b32 v154, v22, v14
  v_and_b32 v155, v22, v15
  v_and_b32 v156, v23, v12
  v_and_b32 v157, v23, v13
  v_and_b32 v158, v23, v14
  v_and_b32 v159, v23, v15
  s_mov_b32 s40, 65536
spin_104:
  ds_read_b32 v62, v1 offset:0
  ds_read_b128 v[64:67], v11 offset:0
  ds_read_b128 v[68:71], v11 offset:1024
  ds_read_b128 v[72:75], v11 offset:2048
  ds_read_b128 v[76:79], v11 offset:3072
  s_sub_u32 s40, s40, 1
  s_cbranch_scc1 L_end
  s_waitcnt lgkmcnt(0)
  v_cmp_gt_u32 vcc, 2, v62
  s_cbranch_vccnz spin_104
  v_mfma_f32_16x16x32_bf16 v[32:35], v[128:131], v[64:67], 0
  v_mfma_f32_16x16x32_bf16 v[32:35], v[132:135], v[68:71], v[32:35]
  v_mfma_f32_16x16x32_bf16 v[32:35], v[136:139], v[72:75], v[32:35]
  v_mfma_f32_16x16x32_bf16 v[32:35], v[140:143], v[76:79], v[32:35]
  s_mov_b32 s40, 65536
spin_105:
  ds_read_b32 v62, v1 offset:0
  ds_read_b128 v[80:83], v11 offset:4096
  ds_read_b128 v[84:87], v11 offset:5120
  ds_read_b128 v[88:91], v11 offset:6144
  ds_read_b128 v[92:95], v11 offset:7168
  s_sub_u32 s40, s40, 1
  s_cbranch_scc1 L_end
  s_waitcnt lgkmcnt(0)
  v_cmp_gt_u32 vcc, 3, v62
  s_cbranch_vccnz spin_105
  v_mfma_f32_16x16x32_bf16 v[32:35], v[144:147], v[80:83], v[32:35]
  v_mfma_f32_16x16x32_bf16 v[32:35], v[148:151], v[84:87], v[32:35]
  v_mfma_f32_16x16x32_bf16 v[32:35], v[152:155], v[88:91], v[32:35]
  v_mfma_f32_16x16x32_bf16 v[32:35], v[156:159], v[92:95], v[32:35]
  v_and_b32 v128, v24, v12
  v_and_b32 v129, v24, v13
  v_and_b32 v130, v24, v14
  v_and_b32 v131, v24, v15
  v_and_b32 v132, v25, v12
  v_and_b32 v133, v25, v13
  v_and_b32 v134, v25, v14
  v_and_b32 v135, v25, v15
  v_and_b32 v136, v26, v12
  v_and_b32 v137, v26, v13
  v_and_b32 v138, v26, v14
  v_and_b32 v139, v26, v15
  v_and_b32 v140, v27, v12
  v_and_b32 v141, v27, v13
  v_and_b32 v142, v27, v14
  v_and_b32 v143, v27, v15
  s_mov_b32 s40, 65536
spin_106:
  ds_read_b32 v62, v1 offset:0
  ds_read_b128 v[96:99], v11 offset:8192
  ds_read_b128 v[100:103], v11 offset:9216
  ds_read_b128 v[104:107], v11 offset:10240
  ds_read_b128 v[108:111], v11 offset:11264
  s_sub_u32 s40, s40, 1
  s_cbranch_scc1 L_end
  s_waitcnt lgkmcnt(0)
  v_cmp_gt_u32 vcc, 4, v62
  s_cbranch_vccnz spin_106
  v_mfma_f32_16x16x32_bf16 v[32:35], v[128:131], v[96:99], v[32:35]
  v_mfma_f32_16x16x32_bf16 v[32:35], v[132:135], v[100:103], v[32:35]
  v_mfma_f32_16x16x32_bf16 v[32:35], v[136:139], v[104:107], v[32:35]
  v_mfma_f32_16x16x32_bf16 v[32:35], v[140:143], v[108:111], v[32:35]
  v_and_b32 v144, v28, v12
  v_and_b32 v145, v28, v13
  v_and_b32 v146, v28, v14
  v_and_b32 v147, v28, v15
  v_and_b32 v148, v29, v12
  v_and_b32 v149, v29, v13
  v_and_b32 v150, v29, v14
  v_and_b32 v151, v29, v15
  v_and_b32 v152, v30, v12
  v_and_b32 v153, v30, v13
  v_and_b32 v154, v30, v14
  v_and_b32 v155, v30, v15
  v_and_b32 v156, v31, v12
  v_and_b32 v157, v31, v13
  v_and_b32 v158, v31, v14
  v_and_b32 v159, v31, v15
  s_mov_b32 s40, 65536
spin_107:
  ds_read_b32 v62, v1 offset:0
  ds_read_b128 v[112:115], v11 offset:12288
  ds_read_b128 v[116:119], v11 offset:13312
  ds_read_b128 v[120:123], v11 offset:14336
  ds_read_b128 v[124:127], v11 offset:15360
  s_sub_u32 s40, s40, 1
  s_cbranch_scc1 L_end
  s_waitcnt lgkmcnt(0)
  v_cmp_gt_u32 vcc, 5, v62
  s_cbranch_vccnz spin_107
  v_mfma_f32_16x16x32_bf16 v[32:35], v[144:147], v[112:115], v[32:35]
  v_mfma_f32_16x16x32_bf16 v[32:35], v[148:151], v[116:119], v[32:35]
  v_mfma_f32_16x16x32_bf16 v[32:35], v[152:155], v[120:123], v[32:35]
  v_mfma_f32_16x16x32_bf16 v[32:35], v[156:159], v[124:127], v[32:35]
  s_nop 7
  v_permlane32_swap_b32 v32, v34
  v_permlane32_swap_b32 v33, v35
  s_nop 0
  v_add_f32_dpp v48, v34, v32 row_shl:8 row_mask:0xf bank_mask:0xf
  v_add_f32_dpp v49, v35, v33 row_shl:8 row_mask:0xf bank_mask:0xf
  v_add_u32 v48, 0x80, v48
  v_add_u32 v49, 0x80, v49
  v_mov_b32 v50, v48
  v_mov_b32 v51, v49
  s_nop 0
  v_permlane32_swap_b32 v48, v50
  v_permlane32_swap_b32 v49, v51
  s_mov_b64 exec, 0x00ff00ff
  v_bfi_b32 v52, v56, v57, v48
  v_bfi_b32 v53, v56, v58, v49
  v_bfi_b32 v54, v56, v59, v50
  v_bfi_b32 v55, v56, v60, v51
  buffer_store_dwordx4 v[52:55], v9, s[48:51], 0 offen
  v_add_u32 v62, 128768, v61
  ds_write_b128 v62, v[48:51] offset:0
  s_mov_b64 exec, -1
  v_mov_b32 v20, 1
  ds_write_b32 v1, v20 offset:8
L_aux2:
  s_cmp_ge_u32 s33, 28
  s_cbranch_scc1 L_dec
  s_lshl_b32 s35, s6, 8
  s_add_u32 s35, s35, 123904
  v_lshl_add_u32 v7, v3, 5, s35
  ds_read_b128 v[16:19], v7
  ds_read_b128 v[20:23], v7 offset:16
  s_lshl_b32 s35, s4, 2
  s_add_u32 s35, s35, s7
  s_lshl_b32 s35, s35, 12
  s_add_u32 s35, s35, 135168
  v_add_u32 v10, s35, v2
  s_lshl_b32 s36, s6, 9
  s_add_u32 s35, s35, s36
  v_lshl_add_u32 v9, v5, 1, s35
  v_add_u32 v11, 65536, v2
  v_bfe_u32 v8, v0, 4, 1
  v_lshlrev_b32 v8, 6, v8
  v_bfe_u32 v6, v0, 1, 2
  v_lshl_add_u32 v8, v6, 4, v8
  v_bfe_u32 v6, v0, 3, 1
  v_lshl_add_u32 v8, v6, 3, v8
  v_and_b32 v6, 1, v0
  v_lshl_add_u32 v8, v6, 2, v8
  v_lshrrev_b32 v6, 5, v0
  v_lshl_add_u32 v8, v6, 1, v8
  v_add_u32 v8, 128640, v8
  s_and_b32 s56, s32, 0xff
  s_bfe_u32 s57, s32, 0x80008
  s_bfe_u32 s58, s32, 0x80010
  s_lshr_b32 s59, s32, 24
  v_mov_b32 v57, s56
  v_mov_b32 v58, s57
  v_mov_b32 v59, s58
  v_mov_b32 v60, s59
  s_waitcnt lgkmcnt(0)
  v_and_b32 v128, v16, v12
  v_and_b32 v129, v16, v13
  v_and_b32 v130, v16, v14
  v_and_b32 v131, v16, v15
  v_and_b32 v132, v17, v12
  v_and_b32 v133, v17, v13
  v_and_b32 v134, v17, v14
  v_and_b32 v135, v17, v15
  v_and_b32 v136, v18, v12
  v_and_b32 v137, v18, v13
  v_and_b32 v138, v18, v14
  v_and_b32 v139, v18, v15
  v_and_b32 v140, v19, v12
  v_and_b32 v141, v19, v13
  v_and_b32 v142, v19, v14
  v_and_b32 v143, v19, v15
  v_and_b32 v144, v20, v12
  v_and_b32 v145, v20, v13
  v_and_b32 v146, v20, v14
  v_and_b32 v147, v20, v15
  v_and_b32 v148, v21, v12
  v_and_b32 v149, v21, v13
  v_and_b32 v150, v21, v14
  v_and_b32 v151, v21, v15
  v_and_b32 v152, v22, v12
  v_and_b32 v153, v22, v13
  v_and_b32 v154, v22, v14
  v_and_b32 v155, v22, v15
  v_and_b32 v156, v23, v12
  v_and_b32 v157, v23, v13
  v_and_b32 v158, v23, v14
  v_and_b32 v159, v23, v15
  s_not_b32 s37, s32
  v_mov_b32 v44, s37
  s_lshl_b32 s33, s6, 4
  s_mov_b32 s40, 65536
spin_109:
  s_sleep 4
  ds_read_b32 v28, v1 offset:0
  s_sub_u32 s40, s40, 1
  s_cbranch_scc1 L_end
  s_waitcnt lgkmcnt(0)
  v_cmp_gt_u32 vcc, 11, v28
  s_cbranch_vccnz spin_109
  s_mov_b64 exec, 1
  buffer_load_dwordx4 v[44:47], off, s[48:51], s33 offset:3072 sc1
  s_mov_b64 exec, -1
  s_mov_b32 s40, 65536
spin_110:
  s_sleep 4
  ds_read_b32 v28, v1 offset:0
  s_sub_u32 s40, s40, 1
  s_cbranch_scc1 L_end
  s_waitcnt lgkmcnt(0)
  v_cmp_gt_u32 vcc, 11, v28
  s_cbranch_vccnz spin_110
  s_mov_b32 s40, 65536
spin_111:
  ds_read_b32 v28, v1 offset:0
  ds_read_b128 v[64:67], v11 offset:0
  ds_read_b128 v[68:71], v11 offset:1024
  ds_read_b128 v[72:75], v11 offset:2048
  ds_read_b128 v[76:79], v11 offset:3072
  s_sub_u32 s40, s40, 1
  s_cbranch_scc1 L_end
  s_waitcnt lgkmcnt(0)
  v_cmp_gt_u32 vcc, 12, v28
  s_cbranch_vccnz spin_111
  v_mfma_f32_16x16x32_bf16 v[32:35], v[128:131], v[64:67], 0
  v_mfma_f32_16x16x32_bf16 v[36:39], v[128:131], v[68:71], 0
  v_mfma_f32_16x16x32_bf16 v[32:35], v[132:135], v[72:75], v[32:35]
  v_mfma_f32_16x16x32_bf16 v[36:39], v[132:135], v[76:79], v[36:39]
  s_mov_b32 s40, 65536
spin_112:
  ds_read_b32 v28, v1 offset:0
  ds_read_b128 v[80:83], v11 offset:4096
  ds_read_b128 v[84:87], v11 offset:5120
  ds_read_b128 v[88:91], v11 offset:6144
  ds_read_b128 v[92:95], v11 offset:7168
  s_sub_u32 s40, s40, 1
  s_cbranch_scc1 L_end
  s_waitcnt lgkmcnt(0)
  v_cmp_gt_u32 vcc, 13, v28
  s_cbranch_vccnz spin_112
  v_mfma_f32_16x16x32_bf16 v[32:35], v[136:139], v[80:83], v[32:35]
  v_mfma_f32_16x16x32_bf16 v[36:39], v[136:139], v[84:87], v[36:39]
  v_mfma_f32_16x16x32_bf16 v[32:35], v[140:143], v[88:91], v[32:35]
  v_mfma_f32_16x16x32_bf16 v[36:39], v[140:143], v[92:95], v[36:39]
  s_mov_b32 s40, 65536
spin_113:
  ds_read_b32 v28, v1 offset:0
  ds_read_b128 v[96:99], v11 offset:8192
  ds_read_b128 v[100:103], v11 offset:9216
  ds_read_b128 v[104:107], v11 offset:10240
  ds_read_b128 v[108:111], v11 offset:11264
  s_sub_u32 s40, s40, 1
  s_cbranch_scc1 L_end
  s_waitcnt lgkmcnt(0)
  v_cmp_gt_u32 vcc, 14, v28
  s_cbranch_vccnz spin_113
  v_mfma_f32_16x16x32_bf16 v[32:35], v[144:147], v[96:99], v[32:35]
  v_mfma_f32_16x16x32_bf16 v[36:39], v[144:147], v[100:103], v[36:39]
  v_mfma_f32_16x16x32_bf16 v[32:35], v[148:151], v[104:107], v[32:35]
  v_mfma_f32_16x16x32_bf16 v[36:39], v[148:151], v[108:111], v[36:39]
  s_mov_b32 s40, 65536
spin_114:
  ds_read_b32 v28, v1 offset:0
  ds_read_b128 v[112:115], v11 offset:12288
  ds_read_b128 v[116:119], v11 offset:13312
  ds_read_b128 v[120:123], v11 offset:14336
  ds_read_b128 v[124:127], v11 offset:15360
  ds_read_b128 v[24:27], v1 offset:16
  s_sub_u32 s40, s40, 1
  s_cbranch_scc1 L_end
  s_waitcnt lgkmcnt(0)
  v_cmp_gt_u32 vcc, 15, v28
  s_cbranch_vccnz spin_114
  v_mfma_f32_16x16x32_bf16 v[32:35], v[152:155], v[112:115], v[32:35]
  v_mfma_f32_16x16x32_bf16 v[36:39], v[152:155], v[116:119], v[36:39]
  v_mfma_f32_16x16x32_bf16 v[32:35], v[156:159], v[120:123], v[32:35]
  v_mfma_f32_16x16x32_bf16 v[36:39], v[156:159], v[124:127], v[36:39]
  v_and_b32 v26, v26, v27
  v_bitop3_b32 v24, v24, v25, v26 bitop3:0x80
  s_nop 0
  v_readfirstlane_b32 s41, v24
  s_nop 0
  s_and_b32 s41, s41, 2
  s_nop 0
  v_permlane32_swap_b32 v32, v34
  v_permlane32_swap_b32 v33, v35
  v_permlane32_swap_b32 v36, v38
  v_permlane32_swap_b32 v37, v39
  v_add_f32_dpp v48, v34, v32 row_shl:8 row_mask:0xf bank_mask:0xf
  v_add_f32_dpp v50, v35, v33 row_shl:8 row_mask:0xf bank_mask:0xf
  v_add_f32_dpp v49, v38, v36 row_shl:8 row_mask:0xf bank_mask:0xf
  v_add_f32_dpp v51, v39, v37 row_shl:8 row_mask:0xf bank_mask:0xf
  s_mov_b32 exec_lo, 0x00ff00ff
  s_mov_b32 exec_hi, 0x00ff00ff
  v_add_u32 v48, 0x80, v48
  v_add_u32 v49, 0x80, v49
  v_add_u32 v50, 0x80, v50
  v_add_u32 v51, 0x80, v51
  v_bfi_b32 v48, v56, v57, v48
  v_bfi_b32 v49, v56, v58, v49
  v_bfi_b32 v50, v56, v59, v50
  v_bfi_b32 v51, v56, v60, v51
  s_cmp_eq_u32 s41, 0
  s_cbranch_scc1 slow_115
  buffer_store_dwordx4 v[48:51], v9, s[48:51], 0 offen
st_116:
  s_mov_b64 exec, -1
  s_mov_b32 s40, 65536
  s_waitcnt vmcnt(1)
L_vc0b:
  s_mov_b64 exec, 1
  v_xor_b32 v44, s32, v44
  v_xor_b32 v45, s32, v45
  v_xor_b32 v46, s32, v46
  v_xor_b32 v47, s32, v47
  s_movk_i32 s39, 0x2000
  v_or_b32 v41, v44, v45
  v_or3_b32 v41, v41, v46, v47
  v_cmp_lt_u32 vcc, 1, v41
  v_lshlrev_b32 v44, v44, s39
  v_lshlrev_b32 v45, v45, s39
  v_lshlrev_b32 v46, v46, s39
  v_lshlrev_b32 v47, v47, s39
  s_cbranch_vccnz L_vc1b
  ds_write_b128 v1, v[44:47] offset:64
  s_mov_b64 exec, -1
  s_mov_b32 s38, 18
  s_mov_b32 s36, 17
  s_mov_b32 s39, 1
  s_mov_b32 s40, 65536
hb_117:
  s_cmp_eq_u32 s39, 1
  s_cbranch_scc0 L_hbg
  s_mov_b32 s40, 65536
spin_118:
  ds_read_b32 v28, v1 offset:0
  s_sub_u32 s40, s40, 1
  s_cbranch_scc1 L_end
  s_waitcnt lgkmcnt(0)
  v_cmp_gt_u32 vcc, s36, v28
  s_cbranch_vccnz spin_118
  s_mov_b32 s40, 65536
L_hbg:
  s_add_u32 s39, s39, 1
  buffer_load_dwordx4 v[64:67], v10, s[48:51], 0 offen offset:0 sc1
  buffer_load_dwordx4 v[68:71], v10, s[48:51], 0 offen offset:1024 sc1
  buffer_load_dwordx4 v[72:75], v10, s[48:51], 0 offen offset:2048 sc1
  buffer_load_dwordx4 v[76:79], v10, s[48:51], 0 offen offset:3072 sc1
  s_sub_u32 s40, s40, 1
  s_cbranch_scc1 L_end
  s_waitcnt vmcnt(3)
  v_xor_b32 v64, s56, v64
  v_xor_b32 v65, s57, v65
  v_xor_b32 v66, s58, v66
  v_xor_b32 v67, s59, v67
  v_or_b32 v20, v64, v65
  v_or3_b32 v20, v20, v66, v67
  s_waitcnt vmcnt(2)
  v_xor_b32 v68, s56, v68
  v_xor_b32 v69, s57, v69
  v_xor_b32 v70, s58, v70
  v_xor_b32 v71, s59, v71
  v_or3_b32 v20, v20, v68, v69
  v_or3_b32 v20, v20, v70, v71
  v_pk_add_f32 v[64:65], v[64:65], v[68:69]
  v_pk_add_f32 v[66:67], v[66:67], v[70:71]
  s_waitcnt vmcnt(1)
  v_xor_b32 v72, s56, v72
  v_xor_b32 v73, s57, v73
  v_xor_b32 v74, s58, v74
  v_xor_b32 v75, s59, v75
  v_or3_b32 v20, v20, v72, v73
  v_or3_b32 v20, v20, v74, v75
  v_pk_add_f32 v[64:65], v[64:65], v[72:73]
  v_pk_add_f32 v[66:67], v[66:67], v[74:75]
  s_waitcnt vmcnt(0)
  v_xor_b32 v76, s56, v76
  v_xor_b32 v77, s57, v77
  v_xor_b32 v78, s58, v78
  v_xor_b32 v79, s59, v79
  v_or3_b32 v20, v20, v76, v77
  v_or3_b32 v20, v20, v78, v79
  v_pk_add_f32 v[64:65], v[64:65], v[76:77]
  v_pk_add_f32 v[66:67], v[66:67], v[78:79]
  v_cmp_ne_u32_sdwa vcc, v20, 0 src0_sel:BYTE_0 src1_sel:DWORD
  s_cbranch_vccnz hb_117
  v_permlane32_swap_b32 v64, v66
  v_permlane32_swap_b32 v65, v67
  v_add_f32 v64, v64, v66
  v_cvt_pk_bf16_f32 v64, 0, v64
  v_mul_f32 v20, 0xbfb8aa3b, v64
  v_exp_f32 v20, v20
  v_add_f32 v66, v65, v67
  v_add_f32 v20, 1.0, v20
  v_rcp_f32 v21, v20
  v_cvt_pk_bf16_f32 v66, 0, v66
  v_mul_f32 v22, v64, v21
  v_cvt_pk_bf16_f32 v22, 0, v22
  v_mul_f32 v22, v22, v66
  v_cvt_pk_bf16_f32 v22, v22, v22
  ds_write_b16 v8, v22
L_adone:
L_adump:
  s_waitcnt lgkmcnt(0)
  s_endpgm
L_ld2:
  s_cbranch_vccnz bo_2
  s_waitcnt vmcnt(18)
bo_2:
  s_waitcnt vmcnt(23)
  buffer_load_dwordx4 v9, s[44:47], s40 offen offset:3072 nt lds
  s_addk_i32 s40, 0x1000
  s_and_b32 s40, s40, 0x7fff
  s_mov_b32 m0, 4096
  s_cbranch_vccnz bo_3
  s_waitcnt vmcnt(18)
bo_3:
  s_waitcnt vmcnt(23)
  buffer_load_dwordx4 v10, s[44:47], s40 offen offset:0 nt lds
  s_cbranch_vccnz bo_4
  s_waitcnt vmcnt(18)
bo_4:
  s_waitcnt vmcnt(23)
  buffer_load_dwordx4 v10, s[44:47], s40 offen offset:1024 nt lds
  s_waitcnt vmcnt(18)
  v_mov_b32 v20, 2
  ds_write_b32 v1, v20 offset:0
  buffer_load_dwordx4 v11, s[44:47], s40 offen offset:2048 nt lds
  v_lshrrev_b32 v4, 2, v2
  v_xor_b32 v4, v4, v3
  v_lshl_add_u32 v12, v4, 6, v5
  v_and_b32 v4, 3, v0
  v_lshl_add_u32 v12, v4, 4, v12
  v_mul_u32_u24 v13, 28672, v6
  v_lshl_add_u32 v13, v7, 4, v13
  v_lshlrev_b32 v4, 1, v3
  v_xor_b32 v4, v4, v7
  v_lshlrev_b32 v4, 4, v4
  v_lshl_add_u32 v14, v6, 10, v4
  s_mul_i32 s41, s6, 229376
  s_lshl_b32 s37, s33, 7
  s_add_u32 s41, s41, s37
  s_lshl_b32 s42, s4, 19
  s_lshl_b32 s38, s7, 17
  s_add_u32 s42, s42, s38
  s_lshl_b32 s38, s6, 7
  s_add_u32 s42, s42, s38
  s_lshl_b32 s43, s33, 16
  s_add_u32 s43, s43, s38
  s_mov_b32 s48, s30
  s_and_b32 s49, s31, 0xffff
  s_mov_b32 s50, 1605632
  s_mov_b32 s51, 0x20000
  s_sub_u32 s37, s33, 28
  s_mul_i32 s37, s37, 2
  s_lshl2_add_u32 s37, s6, s37
  s_and_b32 s36, s37, 0
  s_andn2_b32 s37, s37, 0
  s_lshl1_add_u32 s36, s37, s36
  s_lshl_b32 s36, s36, 13
  s_add_u32 s36, s36, 286720
  v_lshl_add_u32 v19, v0, 8, s36
  s_lshl_b32 s36, s4, 7
  s_add_u32 s36, s36, s5
  s_lshl_b32 s37, s36, 9
  s_add_u32 s37, s37, 819200
  v_lshrrev_b32 v16, 3, v0
  v_lshlrev_b32 v16, 14, v16
  v_lshl_add_u32 v16, v7, 6, v16
  v_add_u32 v16, s37, v16
  s_lshl_b32 s37, s36, 4
  s_add_u32 s37, s37, 266240
  v_and_b32 v17, 3, v0
  v_lshlrev_b32 v17, 9, v17
  v_add_u32 v17, s37, v17
  s_lshl_b32 s36, s4, 2
  s_add_u32 s36, s36, s7
  s_lshl_b32 s36, s36, 3
  s_add_u32 s36, s36, s6
  s_lshl_b32 s36, s36, 9
  s_add_u32 s36, s36, 135168
  v_lshl_add_u32 v18, v7, 6, s36
  v_cmp_gt_u32 s[56:57], 40, v0
  s_nop 1
  v_cndmask_b32 v17, v17, v18, s[56:57]
  v_cmp_gt_u32 s[56:57], 32, v0
  s_nop 1
  v_cndmask_b32 v16, v17, v16, s[56:57]
  s_cbranch_vccnz bo_5
  s_waitcnt vmcnt(18)
bo_5:
  s_waitcnt vmcnt(23)
  buffer_load_dwordx4 v11, s[44:47], s40 offen offset:3072 nt lds
  s_addk_i32 s40, 0x1000
  s_and_b32 s40, s40, 0x7fff
  s_mov_b32 m0, 8192
  s_cbranch_vccnz bo_6
  s_waitcnt vmcnt(18)
bo_6:
  s_waitcnt vmcnt(23)
  buffer_load_dwordx4 v8, s[44:47], s40 offen offset:0 nt lds
  s_cbranch_vccnz bo_7
  s_waitcnt vmcnt(18)
bo_7:
  s_waitcnt vmcnt(23)
  buffer_load_dwordx4 v8, s[44:47], s40 offen offset:1024 nt lds
  s_waitcnt vmcnt(18)
  v_mov_b32 v20, 3
  ds_write_b32 v1, v20 offset:0
  buffer_load_dwordx4 v9, s[44:47], s40 offen offset:2048 nt lds
  s_cbranch_vccnz bo_8
  s_waitcnt vmcnt(18)
bo_8:
  s_waitcnt vmcnt(23)
  buffer_load_dwordx4 v9, s[44:47], s40 offen offset:3072 nt lds
  s_addk_i32 s40, 0x1000
  s_and_b32 s40, s40, 0x7fff
  s_mov_b32 m0, 12288
  s_cbranch_vccnz bo_9
  s_waitcnt vmcnt(18)
bo_9:
  s_waitcnt vmcnt(23)
  buffer_load_dwordx4 v10, s[44:47], s40 offen offset:0 nt lds
  s_cbranch_vccnz bo_10
  s_waitcnt vmcnt(18)
bo_10:
  s_waitcnt vmcnt(23)
  buffer_load_dwordx4 v10, s[44:47], s40 offen offset:1024 nt lds
  s_waitcnt vmcnt(18)
  v_mov_b32 v20, 4
  ds_write_b32 v1, v20 offset:0
  buffer_load_dwordx4 v11, s[44:47], s40 offen offset:2048 nt lds
  s_cbranch_vccnz bo_11
  s_waitcnt vmcnt(18)
bo_11:
  s_waitcnt vmcnt(23)
  buffer_load_dwordx4 v11, s[44:47], s40 offen offset:3072 nt lds
  s_addk_i32 s40, 0x1000
  s_and_b32 s40, s40, 0x7fff
  s_mov_b32 m0, 16384
  s_cbranch_vccnz bo_12
  s_waitcnt vmcnt(18)
bo_12:
  s_waitcnt vmcnt(23)
  buffer_load_dwordx4 v8, s[44:47], s40 offen offset:0 nt lds
  s_cbranch_vccnz bo_13
  s_waitcnt vmcnt(18)
bo_13:
  s_waitcnt vmcnt(23)
  buffer_load_dwordx4 v8, s[44:47], s40 offen offset:1024 nt lds
  s_waitcnt vmcnt(18)
  v_mov_b32 v20, 5
  ds_write_b32 v1, v20 offset:0
  buffer_load_dwordx4 v9, s[44:47], s40 offen offset:2048 nt lds
  s_cbranch_vccnz bo_14
  s_waitcnt vmcnt(18)
bo_14:
  s_waitcnt vmcnt(23)
  buffer_load_dwordx4 v9, s[44:47], s40 offen offset:3072 nt lds
  s_addk_i32 s40, 0x1000
  s_and_b32 s40, s40, 0x7fff
  s_mov_b32 m0, 20480
  s_cbranch_vccnz bo_15
  s_waitcnt vmcnt(18)
bo_15:
  s_waitcnt vmcnt(23)
  buffer_load_dwordx4 v10, s[44:47], s40 offen offset:0 nt lds
  s_cbranch_vccnz bo_16
  s_waitcnt vmcnt(18)
bo_16:
  s_waitcnt vmcnt(23)
  buffer_load_dwordx4 v10, s[44:47], s40 offen offset:1024 nt lds
  s_cbranch_vccnz bo_17
  s_waitcnt vmcnt(18)
bo_17:
  s_waitcnt vmcnt(23)
  buffer_load_dwordx4 v11, s[44:47], s40 offen offset:2048 nt lds
  s_cbranch_vccnz bo_18
  s_waitcnt vmcnt(18)
bo_18:
  s_waitcnt vmcnt(23)
  buffer_load_dwordx4 v11, s[44:47], s40 offen offset:3072 nt lds
  s_addk_i32 s40, 0x1000
  s_and_b32 s40, s40, 0x7fff
  s_mov_b32 m0, 24576
  s_cbranch_vccnz bo_19
  s_waitcnt vmcnt(18)
bo_19:
  s_waitcnt vmcnt(23)
  buffer_load_dwordx4 v8, s[44:47], s40 offen offset:0 nt lds
  s_cbranch_vccnz bo_20
  s_waitcnt vmcnt(18)
bo_20:
  s_waitcnt vmcnt(23)
  buffer_load_dwordx4 v8, s[44:47], s40 offen offset:1024 nt lds
  s_cbranch_vccnz bo_21
  s_waitcnt vmcnt(18)
bo_21:
  s_waitcnt vmcnt(23)
  buffer_load_dwordx4 v9, s[44:47], s40 offen offset:2048 nt lds
  s_cbranch_vccnz bo_22
  s_waitcnt vmcnt(18)
bo_22:
  s_waitcnt vmcnt(23)
  buffer_load_dwordx4 v9, s[44:47], s40 offen offset:3072 nt lds
  s_addk_i32 s40, 0x1000
  s_and_b32 s40, s40, 0x7fff
  s_mov_b32 m0, 28672
  s_cbranch_vccnz bo_23
  s_waitcnt vmcnt(18)
bo_23:
  s_waitcnt vmcnt(23)
  buffer_load_dwordx4 v10, s[44:47], s40 offen offset:0 nt lds
  s_cbranch_vccnz bo_24
  s_waitcnt vmcnt(18)
bo_24:
  s_waitcnt vmcnt(23)
  buffer_load_dwordx4 v10, s[44:47], s40 offen offset:1024 nt lds
  s_cbranch_vccnz bo_25
  s_waitcnt vmcnt(18)
bo_25:
  s_waitcnt vmcnt(23)
  buffer_load_dwordx4 v11, s[44:47], s40 offen offset:2048 nt lds
  s_cbranch_vccnz bo_26
  s_waitcnt vmcnt(18)
bo_26:
  s_waitcnt vmcnt(23)
  buffer_load_dwordx4 v11, s[44:47], s40 offen offset:3072 nt lds
  s_addk_i32 s40, 0x1000
  s_and_b32 s40, s40, 0x7fff
  s_mov_b32 s44, s12
  s_and_b32 s45, s13, 0xffff
  s_mov_b32 s46, 32768
  s_mov_b32 s47, 0x20000
  s_mov_b32 m0, 32768
  s_cbranch_vccnz bo_27
  s_waitcnt vmcnt(18)
bo_27:
  s_waitcnt vmcnt(23)
  buffer_load_dwordx4 v12, s[44:47], s40 offen offset:0 nt lds
  s_cbranch_vccnz bo_28
  s_waitcnt vmcnt(18)
bo_28:
  s_waitcnt vmcnt(23)
  buffer_load_dwordx4 v12, s[44:47], s40 offen offset:1024 nt lds
  s_cbranch_vccnz bo_29
  s_waitcnt vmcnt(18)
bo_29:
  s_waitcnt vmcnt(23)
  buffer_load_dwordx4 v12, s[44:47], s40 offen offset:2048 nt lds
  s_cbranch_vccnz bo_30
  s_waitcnt vmcnt(18)
bo_30:
  s_waitcnt vmcnt(23)
  buffer_load_dwordx4 v12, s[44:47], s40 offen offset:3072 nt lds
  s_addk_i32 s40, 0x1000
  s_and_b32 s40, s40, 0x7fff
  s_mov_b32 m0, 36864
  s_cbranch_vccnz bo_31
  s_waitcnt vmcnt(18)
bo_31:
  s_waitcnt vmcnt(23)
  buffer_load_dwordx4 v12, s[44:47], s40 offen offset:0 nt lds
  s_cbranch_vccnz bo_32
  s_waitcnt vmcnt(18)
bo_32:
  s_waitcnt vmcnt(23)
  buffer_load_dwordx4 v12, s[44:47], s40 offen offset:1024 nt lds
  s_cbranch_vccnz bo_33
  s_waitcnt vmcnt(18)
bo_33:
  s_waitcnt vmcnt(23)
  buffer_load_dwordx4 v12, s[44:47], s40 offen offset:2048 nt lds
  s_cbranch_vccnz bo_34
  s_waitcnt vmcnt(18)
bo_34:
  s_waitcnt vmcnt(23)
  buffer_load_dwordx4 v12, s[44:47], s40 offen offset:3072 nt lds
  s_addk_i32 s40, 0x1000
  s_and_b32 s40, s40, 0x7fff
  s_mov_b32 m0, 40960
  s_cbranch_vccnz bo_35
  s_waitcnt vmcnt(18)
bo_35:
  s_waitcnt vmcnt(23)
  buffer_load_dwordx4 v12, s[44:47], s40 offen offset:0 nt lds
  s_cbranch_vccnz bo_36
  s_waitcnt vmcnt(18)
bo_36:
  s_waitcnt vmcnt(23)
  buffer_load_dwordx4 v12, s[44:47], s40 offen offset:1024 nt lds
  s_cbranch_vccnz bo_37
  s_waitcnt vmcnt(18)
bo_37:
  s_waitcnt vmcnt(23)
  buffer_load_dwordx4 v12, s[44:47], s40 offen offset:2048 nt lds
  s_cbranch_vccnz bo_38
  s_waitcnt vmcnt(18)
bo_38:
  s_waitcnt vmcnt(23)
  buffer_load_dwordx4 v12, s[44:47], s40 offen offset:3072 nt lds
  s_addk_i32 s40, 0x1000
  s_and_b32 s40, s40, 0x7fff
  s_mov_b32 m0, 45056
  s_waitcnt vmcnt(18)
  v_mov_b32 v20, 6
  ds_write_b32 v1, v20 offset:0
  buffer_load_dwordx4 v12, s[44:47], s40 offen offset:0 nt lds
  s_cbranch_vccnz bo_39
  s_waitcnt vmcnt(18)
bo_39:
  s_waitcnt vmcnt(23)
  buffer_load_dwordx4 v12, s[44:47], s40 offen offset:1024 nt lds
  s_cbranch_vccnz bo_40
  s_waitcnt vmcnt(18)
bo_40:
  s_waitcnt vmcnt(23)
  buffer_load_dwordx4 v12, s[44:47], s40 offen offset:2048 nt lds
  s_cbranch_vccnz bo_41
  s_waitcnt vmcnt(18)
bo_41:
  s_waitcnt vmcnt(23)
  buffer_load_dwordx4 v12, s[44:47], s40 offen offset:3072 nt lds
  s_addk_i32 s40, 0x1000
  s_and_b32 s40, s40, 0x7fff
  s_mov_b32 m0, 49152
  s_cbranch_vccnz bo_42
  s_waitcnt vmcnt(18)
bo_42:
  s_waitcnt vmcnt(23)
  buffer_load_dwordx4 v12, s[44:47], s40 offen offset:0 nt lds
  s_cbranch_vccnz bo_43
  s_waitcnt vmcnt(18)
bo_43:
  s_waitcnt vmcnt(23)
  buffer_load_dwordx4 v12, s[44:47], s40 offen offset:1024 nt lds
  s_waitcnt vmcnt(18)
  v_mov_b32 v20, 7
  ds_write_b32 v1, v20 offset:0
  buffer_load_dwordx4 v12, s[44:47], s40 offen offset:2048 nt lds
  s_cbranch_vccnz bo_44
  s_waitcnt vmcnt(18)
bo_44:
  s_waitcnt vmcnt(23)
  buffer_load_dwordx4 v12, s[44:47], s40 offen offset:3072 nt lds
  s_addk_i32 s40, 0x1000
  s_and_b32 s40, s40, 0x7fff
  s_mov_b32 m0, 53248
  s_cbranch_vccnz bo_45
  s_waitcnt vmcnt(18)
bo_45:
  s_waitcnt vmcnt(23)
  buffer_load_dwordx4 v12, s[44:47], s40 offen offset:0 nt lds
  s_cbranch_vccnz bo_46
  s_waitcnt vmcnt(18)
bo_46:
  s_waitcnt vmcnt(23)
  buffer_load_dwordx4 v12, s[44:47], s40 offen offset:1024 nt lds
  s_cbranch_vccnz bo_47
  s_waitcnt vmcnt(18)
bo_47:
  s_waitcnt vmcnt(23)
  buffer_load_dwordx4 v12, s[44:47], s40 offen offset:2048 nt lds
  s_cbranch_vccnz bo_48
  s_waitcnt vmcnt(18)
bo_48:
  s_waitcnt vmcnt(23)
  buffer_load_dwordx4 v12, s[44:47], s40 offen offset:3072 nt lds
  s_addk_i32 s40, 0x1000
  s_and_b32 s40, s40, 0x7fff
  s_mov_b32 m0, 57344
  s_cbranch_vccnz bo_49
  s_waitcnt vmcnt(18)
bo_49:
  s_waitcnt vmcnt(23)
  buffer_load_dwordx4 v12, s[44:47], s40 offen offset:0 nt lds
  s_cbranch_vccnz bo_50
  s_waitcnt vmcnt(18)
bo_50:
  s_waitcnt vmcnt(23)
  buffer_load_dwordx4 v12, s[44:47], s40 offen offset:1024 nt lds
  s_waitcnt vmcnt(18)
  v_mov_b32 v20, 8
  ds_write_b32 v1, v20 offset:0
  buffer_load_dwordx4 v12, s[44:47], s40 offen offset:2048 nt lds
  s_cbranch_vccnz bo_51
  s_waitcnt vmcnt(18)
bo_51:
  s_waitcnt vmcnt(23)
  buffer_load_dwordx4 v12, s[44:47], s40 offen offset:3072 nt lds
  s_addk_i32 s40, 0x1000
  s_and_b32 s40, s40, 0x7fff
  s_mov_b32 m0, 61440
  s_cbranch_vccnz bo_52
  s_waitcnt vmcnt(18)
bo_52:
  s_waitcnt vmcnt(23)
  buffer_load_dwordx4 v12, s[44:47], s40 offen offset:0 nt lds
  s_cbranch_vccnz bo_53
  s_waitcnt vmcnt(18)
bo_53:
  s_waitcnt vmcnt(23)
  buffer_load_dwordx4 v12, s[44:47], s40 offen offset:1024 nt lds
  s_cbranch_vccnz bo_54
  s_waitcnt vmcnt(18)
bo_54:
  s_waitcnt vmcnt(23)
  buffer_load_dwordx4 v12, s[44:47], s40 offen offset:2048 nt lds
  s_cbranch_vccnz bo_55
  s_waitcnt vmcnt(18)
bo_55:
  s_waitcnt vmcnt(23)
  buffer_load_dwordx4 v12, s[44:47], s40 offen offset:3072 nt lds
  s_addk_i32 s40, 0x1000
  s_and_b32 s40, s40, 0x7fff
  s_mov_b32 exec_lo, 1431655765
  s_mov_b32 exec_hi, 3925
  buffer_load_dword v21, v16, s[48:51], 0 offen nt
  s_mov_b64 exec, -1
  s_cmp_ge_u32 s33, 28
  s_cbranch_scc1 L_ldb
  s_mov_b32 s44, s20
  s_and_b32 s45, s21, 0xffff
  s_mov_b32 s46, 1835008
  s_mov_b32 s47, 0x20000
  s_mov_b32 s52, s22
  s_and_b32 s53, s23, 0xffff
  s_mov_b32 s54, 1835008
  s_mov_b32 s55, 0x20000
  s_mov_b64 vcc, -1
  s_mov_b32 m0, 65536
  s_cbranch_vccnz bo_56
  s_waitcnt vmcnt(18)
bo_56:
  s_waitcnt vmcnt(23)
  buffer_load_dwordx4 v13, s[44:47], s41 offen nt lds
  s_mov_b32 m0, 66560
  s_waitcnt vmcnt(18)
  v_mov_b32 v20, 9
  ds_write_b32 v1, v20 offset:0
  buffer_load_dwordx4 v13, s[52:55], s41 offen nt lds
  s_addk_i32 s41, 0xe00
  s_mov_b32 m0, 67584
  s_cbranch_vccnz bo_57
  s_waitcnt vmcnt(18)
bo_57:
  s_waitcnt vmcnt(23)
  buffer_load_dwordx4 v13, s[44:47], s41 offen nt lds
  s_mov_b32 m0, 68608
  s_cbranch_vccnz bo_58
  s_waitcnt vmcnt(18)
bo_58:
  s_waitcnt vmcnt(23)
  buffer_load_dwordx4 v13, s[52:55], s41 offen nt lds
  s_addk_i32 s41, 0xe00
  s_mov_b32 m0, 69632
  s_cbranch_vccnz bo_59
  s_waitcnt vmcnt(18)
bo_59:
  s_waitcnt vmcnt(23)
  buffer_load_dwordx4 v13, s[44:47], s41 offen nt lds
  s_mov_b32 m0, 70656
  s_cbranch_vccnz bo_60
  s_waitcnt vmcnt(18)
bo_60:
  s_waitcnt vmcnt(23)
  buffer_load_dwordx4 v13, s[52:55], s41 offen nt lds
  s_addk_i32 s41, 0xe00
  s_mov_b32 m0, 71680
  s_cbranch_vccnz bo_61
  s_waitcnt vmcnt(18)
bo_61:
  s_waitcnt vmcnt(23)
  buffer_load_dwordx4 v13, s[44:47], s41 offen nt lds
  s_mov_b32 m0, 72704
  s_cbranch_vccnz bo_62
  s_waitcnt vmcnt(18)
bo_62:
  s_waitcnt vmcnt(23)
  buffer_load_dwordx4 v13, s[52:55], s41 offen nt lds
  s_addk_i32 s41, 0xe00
  s_mov_b32 m0, 73728
  s_cbranch_vccnz bo_63
  s_waitcnt vmcnt(18)
bo_63:
  s_waitcnt vmcnt(23)
  buffer_load_dwordx4 v13, s[44:47], s41 offen nt lds
  s_mov_b32 m0, 74752
  s_waitcnt vmcnt(18)
  v_mov_b32 v20, 10
  ds_write_b32 v1, v20 offset:0
  buffer_load_dwordx4 v13, s[52:55], s41 offen nt lds
  s_addk_i32 s41, 0xe00
  s_mov_b32 m0, 75776
  s_cbranch_vccnz bo_64
  s_waitcnt vmcnt(18)
bo_64:
  s_waitcnt vmcnt(23)
  buffer_load_dwordx4 v13, s[44:47], s41 offen nt lds
  s_mov_b32 m0, 76800
  s_cbranch_vccnz bo_65
  s_waitcnt vmcnt(18)
bo_65:
  s_waitcnt vmcnt(23)
  buffer_load_dwordx4 v13, s[52:55], s41 offen nt lds
  s_addk_i32 s41, 0xe00
  s_mov_b32 m0, 77824
  s_cbranch_vccnz bo_66
  s_waitcnt vmcnt(18)
bo_66:
  s_waitcnt vmcnt(23)
  buffer_load_dwordx4 v13, s[44:47], s41 offen nt lds
  s_mov_b32 m0, 78848
  s_cbranch_vccnz bo_67
  s_waitcnt vmcnt(18)
bo_67:
  s_waitcnt vmcnt(23)
  buffer_load_dwordx4 v13, s[52:55], s41 offen nt lds
  s_addk_i32 s41, 0xe00
  s_mov_b32 m0, 79872
  s_cbranch_vccnz bo_68
  s_waitcnt vmcnt(18)
bo_68:
  s_waitcnt vmcnt(23)
  buffer_load_dwordx4 v13, s[44:47], s41 offen nt lds
  s_mov_b32 m0, 80896
  s_cbranch_vccnz bo_69
  s_waitcnt vmcnt(18)
bo_69:
  s_waitcnt vmcnt(23)
  buffer_load_dwordx4 v13, s[52:55], s41 offen nt lds
  s_addk_i32 s41, 0xe00
  s_mov_b32 s44, s16
  s_and_b32 s45, s17, 0xffff
  s_mov_b32 s46, 4194304
  s_mov_b32 s47, 0x20000
  s_mov_b32 m0, 81920
  s_cbranch_vccnz bo_70
  s_waitcnt vmcnt(18)
bo_70:
  s_waitcnt vmcnt(23)
  buffer_load_dwordx4 v14, s[44:47], s42 offen nt lds
  s_addk_i32 s42, 8192
  s_mov_b32 m0, 82944
  s_waitcnt vmcnt(18)
  v_mov_b32 v20, 11
  ds_write_b32 v1, v20 offset:0
  buffer_load_dwordx4 v14, s[44:47], s42 offen nt lds
  s_addk_i32 s42, 8192
  s_mov_b32 m0, 83968
  s_cbranch_vccnz bo_71
  s_waitcnt vmcnt(18)
bo_71:
  s_waitcnt vmcnt(23)
  buffer_load_dwordx4 v14, s[44:47], s42 offen nt lds
  s_addk_i32 s42, 8192
  s_mov_b32 m0, 84992
  s_cbranch_vccnz bo_72
  s_waitcnt vmcnt(18)
bo_72:
  s_waitcnt vmcnt(23)
  buffer_load_dwordx4 v14, s[44:47], s42 offen nt lds
  s_addk_i32 s42, 8192
  s_mov_b32 m0, 86016
  s_cbranch_vccnz bo_73
  s_waitcnt vmcnt(18)
bo_73:
  s_waitcnt vmcnt(23)
  buffer_load_dwordx4 v14, s[44:47], s42 offen nt lds
  s_addk_i32 s42, 8192
  s_mov_b32 m0, 87040
  s_cbranch_vccnz bo_74
  s_waitcnt vmcnt(18)
bo_74:
  s_waitcnt vmcnt(23)
  buffer_load_dwordx4 v14, s[44:47], s42 offen nt lds
  s_addk_i32 s42, 8192
  s_mov_b32 m0, 88064
  s_waitcnt vmcnt(18)
  v_mov_b32 v20, 12
  ds_write_b32 v1, v20 offset:0
  buffer_load_dwordx4 v14, s[44:47], s42 offen nt lds
  s_addk_i32 s42, 8192
  s_mov_b32 m0, 89088
  s_cbranch_vccnz bo_75
  s_waitcnt vmcnt(18)
bo_75:
  s_waitcnt vmcnt(23)
  buffer_load_dwordx4 v14, s[44:47], s42 offen nt lds
  s_addk_i32 s42, 8192
  s_mov_b32 m0, 90112
  s_cbranch_vccnz bo_76
  s_waitcnt vmcnt(18)
bo_76:
  s_waitcnt vmcnt(23)
  buffer_load_dwordx4 v14, s[44:47], s42 offen nt lds
  s_addk_i32 s42, 8192
  s_mov_b32 m0, 91136
  s_cbranch_vccnz bo_77
  s_waitcnt vmcnt(18)
bo_77:
  s_waitcnt vmcnt(23)
  buffer_load_dwordx4 v14, s[44:47], s42 offen nt lds
  s_addk_i32 s42, 8192
  s_mov_b32 m0, 92160
  s_waitcnt vmcnt(18)
  v_mov_b32 v20, 13
  ds_write_b32 v1, v20 offset:0
  buffer_load_dwordx4 v14, s[44:47], s42 offen nt lds
  s_addk_i32 s42, 8192
  s_mov_b32 m0, 93184
  s_cbranch_vccnz bo_78
  s_waitcnt vmcnt(18)
bo_78:
  s_waitcnt vmcnt(23)
  buffer_load_dwordx4 v14, s[44:47], s42 offen nt lds
  s_addk_i32 s42, 8192
  s_mov_b32 m0, 94208
  s_cbranch_vccnz bo_79
  s_waitcnt vmcnt(18)
bo_79:
  s_waitcnt vmcnt(23)
  buffer_load_dwordx4 v14, s[44:47], s42 offen nt lds
  s_addk_i32 s42, 8192
  s_mov_b32 m0, 95232
  s_cbranch_vccnz bo_80
  s_waitcnt vmcnt(18)
bo_80:
  s_waitcnt vmcnt(23)
  buffer_load_dwordx4 v14, s[44:47], s42 offen nt lds
  s_addk_i32 s42, 8192
  s_mov_b32 m0, 96256
  s_waitcnt vmcnt(18)
  v_mov_b32 v20, 14
  ds_write_b32 v1, v20 offset:0
  buffer_load_dwordx4 v14, s[44:47], s42 offen nt lds
  s_addk_i32 s42, 8192
  s_mov_b32 m0, 97280
  s_cbranch_vccnz bo_81
  s_waitcnt vmcnt(18)
bo_81:
  s_waitcnt vmcnt(23)
  buffer_load_dwordx4 v14, s[44:47], s42 offen nt lds
  s_mov_b32 s44, s24
  s_and_b32 s45, s25, 0xffff
  s_mov_b32 s46, 1835008
  s_mov_b32 s47, 0x20000
  s_mov_b32 m0, 98304
  s_cbranch_vccnz bo_82
  s_waitcnt vmcnt(18)
bo_82:
  s_waitcnt vmcnt(23)
  buffer_load_dwordx4 v14, s[44:47], s43 offen nt lds
  s_addk_i32 s43, 8192
  s_mov_b32 m0, 99328
  s_cbranch_vccnz bo_83
  s_waitcnt vmcnt(18)
bo_83:
  s_waitcnt vmcnt(23)
  buffer_load_dwordx4 v14, s[44:47], s43 offen nt lds
  s_addk_i32 s43, 8192
  s_mov_b32 m0, 100352
  s_waitcnt vmcnt(18)
  v_mov_b32 v20, 15
  ds_write_b32 v1, v20 offset:0
  buffer_load_dwordx4 v14, s[44:47], s43 offen nt lds
  s_addk_i32 s43, 8192
  s_mov_b32 m0, 101376
  s_cbranch_vccnz bo_84
  s_waitcnt vmcnt(18)
bo_84:
  s_waitcnt vmcnt(23)
  buffer_load_dwordx4 v14, s[44:47], s43 offen nt lds
  s_addk_i32 s43, 8192
  s_mov_b32 m0, 102400
  s_cbranch_vccnz bo_85
  s_waitcnt vmcnt(18)
bo_85:
  s_waitcnt vmcnt(23)
  buffer_load_dwordx4 v14, s[44:47], s43 offen nt lds
  s_addk_i32 s43, 8192
  s_mov_b32 m0, 103424
  s_cbranch_vccnz bo_86
  s_waitcnt vmcnt(18)
bo_86:
  s_waitcnt vmcnt(23)
  buffer_load_dwordx4 v14, s[44:47], s43 offen nt lds
  s_addk_i32 s43, 8192
  s_mov_b32 m0, 104448
  s_cbranch_vccnz bo_87
  s_waitcnt vmcnt(18)
bo_87:
  s_waitcnt vmcnt(23)
  buffer_load_dwordx4 v14, s[44:47], s43 offen nt lds
  s_addk_i32 s43, 8192
  s_mov_b32 m0, 105472
  s_cbranch_vccnz bo_88
  s_waitcnt vmcnt(18)
bo_88:
  s_waitcnt vmcnt(23)
  buffer_load_dwordx4 v14, s[44:47], s43 offen nt lds
  s_waitcnt vmcnt(8)
  v_mov_b32 v20, 17
  ds_write_b32 v1, v20 offset:0
  s_waitcnt vmcnt(0)
  v_mov_b32 v20, 18
  ds_write_b32 v1, v20 offset:0
  s_branch L_lde
L_ldb:
  s_mov_b32 s44, s16
  s_and_b32 s45, s17, 0xffff
  s_mov_b32 s46, 4194304
  s_mov_b32 s47, 0x20000
  s_mov_b32 m0, 81920
  s_cbranch_vccnz bo_89
  s_waitcnt vmcnt(18)
bo_89:
  s_waitcnt vmcnt(23)
  buffer_load_dwordx4 v14, s[44:47], s42 offen nt lds
  s_addk_i32 s42, 8192
  s_mov_b32 m0, 82944
  s_waitcnt vmcnt(18)
  v_mov_b32 v20, 9
  ds_write_b32 v1, v20 offset:0
  buffer_load_dwordx4 v14, s[44:47], s42 offen nt lds
  s_addk_i32 s42, 8192
  s_mov_b32 m0, 83968
  s_cbranch_vccnz bo_90
  s_waitcnt vmcnt(18)
bo_90:
  s_waitcnt vmcnt(23)
  buffer_load_dwordx4 v14, s[44:47], s42 offen nt lds
  s_addk_i32 s42, 8192
  s_mov_b32 m0, 84992
  s_cbranch_vccnz bo_91
  s_waitcnt vmcnt(18)
bo_91:
  s_waitcnt vmcnt(23)
  buffer_load_dwordx4 v14, s[44:47], s42 offen nt lds
  s_addk_i32 s42, 8192
  s_mov_b32 m0, 86016
  s_cbranch_vccnz bo_92
  s_waitcnt vmcnt(18)
bo_92:
  s_waitcnt vmcnt(23)
  buffer_load_dwordx4 v14, s[44:47], s42 offen nt lds
  s_addk_i32 s42, 8192
  s_mov_b32 m0, 87040
  s_cbranch_vccnz bo_93
  s_waitcnt vmcnt(18)
bo_93:
  s_waitcnt vmcnt(23)
  buffer_load_dwordx4 v14, s[44:47], s42 offen nt lds
  s_addk_i32 s42, 8192
  s_mov_b32 m0, 88064
  s_cbranch_vccnz bo_94
  s_waitcnt vmcnt(18)
bo_94:
  s_waitcnt vmcnt(23)
  buffer_load_dwordx4 v14, s[44:47], s42 offen nt lds
  s_addk_i32 s42, 8192
  s_mov_b32 m0, 89088
  s_cbranch_vccnz bo_95
  s_waitcnt vmcnt(18)
bo_95:
  s_waitcnt vmcnt(23)
  buffer_load_dwordx4 v14, s[44:47], s42 offen nt lds
  s_addk_i32 s42, 8192
  s_mov_b32 m0, 90112
  s_cbranch_vccnz bo_96
  s_waitcnt vmcnt(18)
bo_96:
  s_waitcnt vmcnt(23)
  buffer_load_dwordx4 v14, s[44:47], s42 offen nt lds
  s_addk_i32 s42, 8192
  s_mov_b32 m0, 91136
  s_waitcnt vmcnt(18)
  v_mov_b32 v20, 10
  ds_write_b32 v1, v20 offset:0
  buffer_load_dwordx4 v14, s[44:47], s42 offen nt lds
  s_addk_i32 s42, 8192
  s_mov_b32 m0, 92160
  s_cbranch_vccnz bo_97
  s_waitcnt vmcnt(18)
bo_97:
  s_waitcnt vmcnt(23)
  buffer_load_dwordx4 v14, s[44:47], s42 offen nt lds
  s_addk_i32 s42, 8192
  s_mov_b32 m0, 93184
  s_cbranch_vccnz bo_98
  s_waitcnt vmcnt(18)
bo_98:
  s_waitcnt vmcnt(23)
  buffer_load_dwordx4 v14, s[44:47], s42 offen nt lds
  s_addk_i32 s42, 8192
  s_mov_b32 m0, 94208
  s_cbranch_vccnz bo_99
  s_waitcnt vmcnt(18)
bo_99:
  s_waitcnt vmcnt(23)
  buffer_load_dwordx4 v14, s[44:47], s42 offen nt lds
  s_addk_i32 s42, 8192
  s_mov_b32 m0, 95232
  s_cbranch_vccnz bo_100
  s_waitcnt vmcnt(18)
bo_100:
  s_waitcnt vmcnt(23)
  buffer_load_dwordx4 v14, s[44:47], s42 offen nt lds
  s_addk_i32 s42, 8192
  s_mov_b32 m0, 96256
  s_cbranch_vccnz bo_101
  s_waitcnt vmcnt(18)
bo_101:
  s_waitcnt vmcnt(23)
  buffer_load_dwordx4 v14, s[44:47], s42 offen nt lds
  s_addk_i32 s42, 8192
  s_mov_b32 m0, 97280
  s_cbranch_vccnz bo_102
  s_waitcnt vmcnt(18)
bo_102:
  s_waitcnt vmcnt(23)
  buffer_load_dwordx4 v14, s[44:47], s42 offen nt lds
  s_waitcnt vmcnt(17)
  v_mov_b32 v20, 11
  ds_write_b32 v1, v20 offset:0
  s_waitcnt vmcnt(8)
  v_mov_b32 v20, 17
  ds_write_b32 v1, v20 offset:0
  s_waitcnt vmcnt(0)
  v_mov_b32 v20, 18
  ds_write_b32 v1, v20 offset:0
L_ldw:
  ds_read_b32 v22, v1 offset:12
  s_waitcnt lgkmcnt(0)
  v_readfirstlane_b32 s36, v22
  s_nop 0
  s_cmp_eq_u32 s36, 0
  s_cbranch_scc1 L_lde
  s_mov_b32 exec_hi, 0
  s_nop 0
  buffer_load_dword v22, v19, s[48:51], s36 offen sc1
  s_addk_i32 s36, 0x4000
  buffer_load_dword v22, v19, s[48:51], s36 offen sc1
L_lde:
  s_endpgm
L_comp:
  s_sub_u32 s34, s3, 2
  s_load_dword s32, s[30:31], 0
  s_mov_b32 s48, s30
  s_and_b32 s49, s31, 0xffff
  s_mov_b32 s50, 1605632
  s_mov_b32 s51, 0x20000
  s_cmp_eq_u32 s34, 1
  s_cbranch_scc0 L_nowarm
  s_lshl_b32 s35, s4, 5
  s_lshl_b32 s36, s6, 2
  s_add_u32 s35, s35, s36
  s_add_u32 s35, s35, s7
  s_lshl_b32 s35, s35, 8
  s_add_u32 s35, s35, 4096
  v_lshlrev_b32 v4, 6, v0
  s_mov_b64 exec, 15
  buffer_load_dword v124, v4, s[48:51], s35 offen nt
  s_mov_b64 exec, -1
L_nowarm:
  v_and_b32 v2, 15, v0
  v_lshrrev_b32 v3, 4, v0
  v_xor_b32 v4, v2, v3
  v_lshlrev_b32 v4, 4, v4
  v_lshrrev_b32 v5, 2, v2
  v_lshlrev_b32 v5, 11, v5
  v_and_b32 v6, 3, v0
  v_lshl_add_u32 v5, v6, 8, v5
  s_lshr_b32 s35, s34, 1
  s_lshl_b32 s35, s35, 14
  s_and_b32 s36, s34, 1
  s_lshl_b32 s36, s36, 10
  s_add_u32 s35, s35, s36
  v_add_u32 v5, s35, v5
  v_xor_b32 v8, 0, v4
  v_add_u32 v8, v8, v5
  v_xor_b32 v9, 64, v4
  v_add_u32 v9, v9, v5
  v_xor_b32 v10, 128, v4
  v_add_u32 v10, v10, v5
  v_xor_b32 v11, 192, v4
  v_add_u32 v11, v11, v5
  v_lshrrev_b32 v4, 2, v2
  v_xor_b32 v5, s34, v4
  v_lshlrev_b32 v5, 6, v5
  v_lshl_add_u32 v5, v4, 8, v5
  v_lshrrev_b32 v7, 1, v3
  v_lshl_add_u32 v5, v7, 10, v5
  v_and_b32 v7, 1, v3
  v_lshl_add_u32 v5, v7, 5, v5
  v_lshl_add_u32 v5, v6, 3, v5
  v_add_u32 v12, 32768, v5
  v_lshl_add_u32 v5, v3, 2, v4
  v_lshrrev_b32 v7, 1, v5
  v_and_b32 v7, 3, v7
  v_xor_b32 v7, s34, v7
  v_lshlrev_b32 v7, 5, v7
  v_lshl_add_u32 v7, v5, 7, v7
  v_lshl_add_u32 v14, v6, 3, v7
  v_add_u32 v14, 81920, v14
  v_mul_u32_u24 v15, 320, v6
  v_lshl_add_u32 v15, v3, 4, v15
  v_add_u32 v15, 125952, v15
  v_lshrrev_b32 v4, 5, v0
  v_lshlrev_b32 v16, 8, v4
  v_and_b32 v5, 1, v3
  v_lshl_add_u32 v16, v5, 10, v16
  v_lshl_add_u32 v16, v2, 4, v16
  s_lshl_b32 s35, s4, 13
  s_lshl_b32 s36, s34, 11
  s_add_u32 s35, s35, s36
  s_add_u32 s35, s35, 4096
  v_add_u32 v16, s35, v16
  s_mul_i32 s35, s34, 320
  s_add_u32 s35, s35, 125952
  v_and_b32 v5, 31, v0
  v_lshl_add_u32 v17, v5, 3, s35
  v_lshl_add_u32 v17, v4, 2, v17
  s_lshl_b32 s35, s34, 2
  v_add_u32 v18, s35, v1
  s_lshl_b32 s35, s34, 8
  s_add_u32 s35, s35, 127232
  v_lshl_add_u32 v19, v3, 5, s35
  v_lshl_add_u32 v19, v6, 3, v19
  v_bfe_u32 v7, v0, 3, 1
  v_lshl_add_u32 v19, v7, 7, v19
  v_bfe_u32 v7, v0, 2, 1
  v_lshl_add_u32 v19, v7, 2, v19
  s_mov_b32 s44, 0xff00ff00
  s_mov_b32 s45, s44
  s_mov_b32 s46, 0xf0f0f0f0
  s_mov_b32 s47, s46
  s_lshl_b32 s35, s34, 4
  s_add_u32 s35, s35, 128256
  v_lshl_add_u32 v112, v0, 2, s35
  v_lshlrev_b32 v113, 3, v0
  v_add_u32 v113, 127232, v113
  v_lshlrev_b32 v114, 4, v4
  v_add_u32 v114, 128256, v114
  s_lshl_b32 s35, s34, 2
  s_add_u32 s35, s35, 128256
  v_lshl_add_u32 v13, v6, 4, s35
  v_mov_b32 v144, 128256
  s_lshl_b32 s35, s4, 7
  s_add_u32 s35, s35, s5
  s_lshl_b32 s36, s35, 9
  s_lshl_b32 s37, s34, 7
  s_add_u32 s36, s36, s37
  s_add_u32 s36, s36, 819200
  v_lshl_add_u32 v115, v5, 2, s36
  v_lshl_add_u32 v115, v4, 14, v115
  s_lshl_b32 s36, s34, 5
  s_add_u32 s36, s36, s35
  s_lshl_b32 s36, s36, 4
  s_add_u32 s36, s36, 266240
  v_mov_b32 v116, s36
  v_lshrrev_b32 v4, 3, v0
  v_and_b32 v5, 7, v0
  s_lshl_b32 s35, s4, 2
  s_add_u32 s35, s35, s7
  s_lshl_b32 s36, s35, 14
  s_lshl_b32 s37, s34, 7
  s_add_u32 s36, s36, s37
  s_add_u32 s36, s36, 819200
  v_lshlrev_b32 v117, 9, v4
  v_lshl_add_u32 v117, v5, 4, v117
  v_add_u32 v117, s36, v117
  s_lshl_b32 s36, s35, 9
  s_add_u32 s36, s36, 266240
  v_and_b32 v118, 31, v0
  v_lshl_add_u32 v118, v118, 4, s36
  v_lshlrev_b32 v123, 2, v4
  v_and_b32 v119, 3, v0
  v_lshlrev_b32 v119, 4, v119
  v_bfe_u32 v4, v0, 2, 1
  v_lshl_add_u32 v119, v4, 3, v119
  v_bfe_u32 v4, v0, 4, 1
  v_lshl_add_u32 v119, v4, 2, v119
  v_lshrrev_b32 v4, 5, v0
  v_lshl_add_u32 v119, v4, 1, v119
  s_lshl_b32 s35, s34, 6
  s_add_u32 s35, s35, 128384
  v_add_u32 v119, s35, v119
  v_lshlrev_b32 v120, 4, v3
  v_add_u32 v120, 128384, v120
  s_lshl2_add_u32 s37, s6, s34
  s_and_b32 s35, s37, 0
  s_andn2_b32 s37, s37, 0
  s_lshl1_add_u32 s35, s37, s35
  s_lshl_b32 s35, s35, 13
  s_add_u32 s35, s35, 286720
  s_lshl2_add_u32 s36, s4, s7
  s_lshl_b32 s36, s36, 8
  s_add_u32 s35, s35, s36
  v_lshl_add_u32 v121, v0, 2, s35
  s_movk_i32 s52, 0x1000
  s_movk_i32 s53, 0x2000
  s_movk_i32 s54, 0x3000
  s_mov_b32 s55, 0x8000
  v_mov_b32 v125, 0xff
  s_waitcnt lgkmcnt(0)
  s_add_u32 s32, s32, 0x9e3779b9
  s_getreg_b32 s42, hwreg(HW_REG_XCC_ID, 0, 4)
  s_add_u32 s42, s42, 1
  s_mul_i32 s42, s42, 0x01010101
  s_xor_b32 s42, s42, s32
  v_lshlrev_b32 v4, 3, v6
  v_lshrrev_b32 v122, v4, s32
  v_mov_b32 v147, s32
  v_mov_b32 v149, s32
  s_and_b32 s56, s42, 0xff
  s_bfe_u32 s57, s42, 0x80008
  s_bfe_u32 s58, s42, 0x80010
  s_lshr_b32 s59, s42, 24
  s_mov_b32 s43, 0
  s_mov_b32 s41, 3
  s_mov_b32 s39, 0
  s_mov_b32 s40, 65536
spin_119:
  s_sleep 4
  ds_read_b32 v20, v1 offset:0
  s_sub_u32 s40, s40, 1
  s_cbranch_scc1 L_end
  s_waitcnt lgkmcnt(0)
  v_cmp_gt_u32 vcc, 6, v20
  s_cbranch_vccnz spin_119
h1_120:
  s_cmp_ge_u32 s39, 8
  s_cbranch_scc1 L_h1sw
h1k_121:
  buffer_load_dwordx4 v[96:99], v16, s[48:51], s43 offen offset:0 sc1
  buffer_load_dwordx4 v[100:103], v16, s[48:51], s43 offen offset:512 sc1
  s_add_u32 s39, s39, 1
  s_cmp_gt_u32 s39, 65536
  s_cbranch_scc1 L_end
  s_mov_b32 s40, 65536
spin_123:
  ds_read_b32 v20, v1 offset:0
  ds_read_b128 v[32:35], v8 offset:0
  ds_read_b128 v[36:39], v9 offset:0
  ds_read_b128 v[40:43], v10 offset:0
  ds_read_b128 v[44:47], v11 offset:0
  ds_read_b128 v[48:51], v8 offset:8192
  ds_read_b128 v[52:55], v9 offset:8192
  ds_read_b128 v[56:59], v10 offset:8192
  ds_read_b128 v[60:63], v11 offset:8192
  s_sub_u32 s40, s40, 1
  s_cbranch_scc1 L_end
  s_waitcnt lgkmcnt(0)
  v_cmp_gt_u32 vcc, 7, v20
  s_cbranch_vccnz spin_123
  s_waitcnt vmcnt(0)
  v_xor_b32 v96, s56, v96
  v_xor_b32 v97, s57, v97
  v_xor_b32 v98, s58, v98
  v_xor_b32 v99, s59, v99
  v_xor_b32 v100, s56, v100
  v_xor_b32 v101, s57, v101
  v_xor_b32 v102, s58, v102
  v_xor_b32 v103, s59, v103
  v_or_b32 v20, v96, v97
  v_or3_b32 v20, v20, v98, v99
  v_or3_b32 v20, v20, v100, v101
  v_or3_b32 v20, v20, v102, v103
  v_add_f32 v96, v96, v100
  v_add_f32 v97, v97, v101
  v_add_f32 v98, v98, v102
  v_add_f32 v99, v99, v103
  v_cmp_ne_u32_sdwa vcc, v20, 0 src0_sel:BYTE_0 src1_sel:DWORD
  v_permlane32_swap_b32 v96, v98
  v_permlane32_swap_b32 v97, v99
  s_cbranch_vccnz h1_120
  v_add_f32 v96, v96, v98
  v_add_f32 v97, v97, v99
  v_mov_b32 v21, s41
  v_cvt_pk_bf16_f32 v96, v96, v97
  ds_write_b32 v17, v96
  ds_write_b32 v18, v21 offset:16
  s_and_b32 s56, s32, 0xff
  s_bfe_u32 s57, s32, 0x80008
  s_bfe_u32 s58, s32, 0x80010
  s_lshr_b32 s59, s32, 24
  s_mov_b32 s40, 65536
spin_124:
  ds_read_b128 v[20:23], v1 offset:16
  ds_read_b128 v[96:99], v15 offset:0
  ds_read_b128 v[100:103], v15 offset:64
  ds_read_b128 v[104:107], v15 offset:128
  ds_read_b128 v[108:111], v15 offset:192
  s_sub_u32 s40, s40, 1
  s_cbranch_scc1 L_end
  s_waitcnt lgkmcnt(0)
  v_and_b32 v22, v22, v23
  v_bitop3_b32 v20, v20, v21, v22 bitop3:0x80
  v_cmp_eq_u32 vcc, 0, v20
  s_cbranch_vccnz spin_124
  v_mfma_f32_16x16x32_bf16 v[24:27], v[32:35], v[96:99], 0
  v_mfma_f32_16x16x32_bf16 v[28:31], v[48:51], v[96:99], 0
  v_mfma_f32_16x16x32_bf16 v[24:27], v[36:39], v[100:103], v[24:27]
  v_mfma_f32_16x16x32_bf16 v[28:31], v[52:55], v[100:103], v[28:31]
  v_mfma_f32_16x16x32_bf16 v[24:27], v[40:43], v[104:107], v[24:27]
  v_mfma_f32_16x16x32_bf16 v[28:31], v[56:59], v[104:107], v[28:31]
  v_mfma_f32_16x16x32_bf16 v[24:27], v[44:47], v[108:111], v[24:27]
  v_mfma_f32_16x16x32_bf16 v[28:31], v[60:63], v[108:111], v[28:31]
  v_readfirstlane_b32 s41, v20
  s_nop 0
  s_and_b32 s41, s41, 2
  s_mov_b32 s38, 0
  s_mov_b32 s35, 0x3db504f3
  s_mov_b32 s36, 0x3fb8aa3b
  s_mov_b32 s60, s35
  s_mov_b32 s61, s35
  s_mov_b32 s62, s36
  s_mov_b32 s63, s36
  v_cndmask_b32 v24, v24, v28, s[44:45]
  v_cndmask_b32 v25, v25, v29, s[44:45]
  v_cndmask_b32 v26, v26, v30, s[44:45]
  v_cndmask_b32 v27, v27, v31, s[44:45]
  v_cndmask_b32 v24, v24, v26, s[46:47]
  v_cndmask_b32 v25, v25, v27, s[46:47]
  v_cvt_pk_bf16_f32 v24, 0, v24
  v_cvt_pk_bf16_f32 v25, 0, v25
  v_pk_mul_f32 v[24:25], v[24:25], s[60:61]
  v_cvt_pk_bf16_f32 v24, 0, v24
  v_cvt_pk_bf16_f32 v25, 0, v25
  v_max_f32 v20, v24, v25
  s_nop 1
  v_max_f32_dpp v20, v20, v20 row_ror:4 row_mask:0xf bank_mask:0xf
  s_nop 1
  v_max_f32_dpp v20, v20, v20 row_ror:8 row_mask:0xf bank_mask:0xf
  v_mov_b32 v21, v20
  s_nop 1
  v_permlane16_swap_b32 v20, v21
  v_max_f32 v20, v20, v21
  v_mov_b32 v21, v20
  s_nop 1
  v_permlane32_swap_b32 v20, v21
  v_max_f32 v20, v20, v21
  v_mul_f32 v22, s62, v20
  v_pk_fma_f32 v[24:25], v[24:25], s[62:63], v[22:23] op_sel:[0,0,0] op_sel_hi:[1,1,0] neg_lo:[0,0,1] neg_hi:[0,0,1]
  v_exp_f32 v24, v24
  v_exp_f32 v25, v25
  s_nop 0
  v_add_f32 v23, v24, v25
  v_cvt_pk_bf16_f32 v32, v24, v25
  ds_write_b32 v19, v32
  v_add_f32_dpp v23, v23, v23 row_ror:4 row_mask:0xf bank_mask:0xf
  s_nop 1
  v_add_f32_dpp v23, v23, v23 row_ror:8 row_mask:0xf bank_mask:0xf
  v_mov_b32 v21, v23
  s_nop 1
  v_permlane16_swap_b32 v23, v21
  v_add_f32 v23, v23, v21
  v_mov_b32 v21, v23
  s_nop 1
  v_permlane32_swap_b32 v23, v21
  v_add_f32 v23, v23, v21
  v_mov_b32 v21, 1
  s_mov_b64 exec, 15
  ds_write2_b32 v112, v22, v23 offset0:0 offset1:16
  s_mov_b64 exec, -1
  ds_write_b32 v18, v21 offset:32
  s_mov_b32 s40, 65536
spin_125:
  ds_read_b128 v[20:23], v1 offset:32
  ds_read2_b32 v[150:151], v13 offset0:0 offset1:16
  ds_read_b32 v145, v1 offset:0
  s_sub_u32 s40, s40, 1
  s_cbranch_scc1 L_end
  s_waitcnt lgkmcnt(0)
  v_and_b32 v22, v22, v23
  v_bitop3_b32 v20, v20, v21, v22 bitop3:0x80
  v_cmp_eq_u32 vcc, 0, v20
  s_cbranch_vccnz spin_125
  v_readfirstlane_b32 s37, v145
  v_max_f32_dpp v146, v150, v150 quad_perm:[1,0,3,2] row_mask:0xf bank_mask:0xf
  ds_read_b64 v[32:33], v113 offset:0
  ds_read_b64 v[34:35], v113 offset:512
  v_max_f32_dpp v146, v146, v146 quad_perm:[2,3,0,1] row_mask:0xf bank_mask:0xf
  v_sub_f32 v150, v150, v146
  v_exp_f32 v150, v150
  ds_read_b128 v[96:99], v144 offset:0
  v_mul_f32 v148, v150, v151
  ds_read_b128 v[100:103], v144 offset:16
  ds_read_b128 v[104:107], v144 offset:32
  v_add_f32_dpp v148, v148, v148 quad_perm:[1,0,3,2] row_mask:0xf bank_mask:0xf
  ds_read_b128 v[108:111], v144 offset:48
  ds_read_b128 v[56:59], v114 offset:0
  v_add_f32_dpp v148, v148, v148 quad_perm:[2,3,0,1] row_mask:0xf bank_mask:0xf
  ds_read_b128 v[60:63], v114 offset:32
  s_mov_b64 exec, 1
  s_cmp_eq_u32 s41, 0
  s_cbranch_scc1 slow_126
  buffer_store_dwordx4 v[146:149], v116, s[48:51], 0 offen
st_127:
  s_mov_b64 exec, -1
  s_cmp_lt_u32 s37, 8
  s_cbranch_scc1 L_vbd
  ds_read_b64_tr_b16 v[64:65], v12 offset:0
  ds_read_b64_tr_b16 v[66:67], v12 offset:2048
  ds_read_b64_tr_b16 v[68:69], v12 offset:4096
  ds_read_b64_tr_b16 v[70:71], v12 offset:6144
  s_cmp_lt_u32 s37, 9
  s_cbranch_scc1 L_vbd
  ds_read_b64_tr_b16 v[72:73], v12 offset:8192
  ds_read_b64_tr_b16 v[74:75], v12 offset:10240
  ds_read_b64_tr_b16 v[76:77], v12 offset:12288
  ds_read_b64_tr_b16 v[78:79], v12 offset:14336
  s_cmp_lt_u32 s37, 10
  s_cbranch_scc1 L_vbd
  ds_read_b64_tr_b16 v[80:81], v12 offset:16384
  ds_read_b64_tr_b16 v[82:83], v12 offset:18432
  ds_read_b64_tr_b16 v[84:85], v12 offset:20480
  ds_read_b64_tr_b16 v[86:87], v12 offset:22528
  s_cmp_lt_u32 s37, 11
  s_cbranch_scc1 L_vbd
  ds_read_b64_tr_b16 v[88:89], v12 offset:24576
  ds_read_b64_tr_b16 v[90:91], v12 offset:26624
  ds_read_b64_tr_b16 v[92:93], v12 offset:28672
  ds_read_b64_tr_b16 v[94:95], v12 offset:30720
L_vbd:
  s_waitcnt lgkmcnt(0)
  s_cmp_lt_u32 s37, 8
  s_cbranch_scc1 L_vw0
L_vr0:
  v_mfma_f32_4x4x4_16b_bf16 v[40:43], v[32:33], v[64:65], 0 cbsz:3 abid:0
  v_max3_f32 v96, v96, v100, v104
  v_max3_f32 v97, v97, v101, v105
  v_max3_f32 v98, v98, v102, v106
  v_max3_f32 v99, v99, v103, v107
  v_mfma_f32_4x4x4_16b_bf16 v[44:47], v[32:33], v[66:67], 0 cbsz:3 abid:1
  v_max_f32 v96, v96, v108
  v_max_f32 v97, v97, v109
  v_max_f32 v98, v98, v110
  v_max_f32 v99, v99, v111
  v_mfma_f32_4x4x4_16b_bf16 v[40:43], v[32:33], v[68:69], v[40:43] cbsz:3 abid:2
  v_sub_f32 v56, v56, v96
  v_sub_f32 v57, v57, v97
  v_sub_f32 v58, v58, v98
  v_sub_f32 v59, v59, v99
  v_mfma_f32_4x4x4_16b_bf16 v[44:47], v[32:33], v[70:71], v[44:47] cbsz:3 abid:3
  v_sub_f32 v60, v60, v96
  v_sub_f32 v61, v61, v97
  v_sub_f32 v62, v62, v98
  v_sub_f32 v63, v63, v99
  s_cmp_lt_u32 s37, 9
  s_cbranch_scc1 L_vw1
L_vr1:
  v_mfma_f32_4x4x4_16b_bf16 v[40:43], v[32:33], v[72:73], v[40:43] cbsz:3 abid:4
  v_exp_f32 v56, v56
  v_exp_f32 v57, v57
  v_exp_f32 v58, v58
  v_exp_f32 v59, v59
  v_mfma_f32_4x4x4_16b_bf16 v[44:47], v[32:33], v[74:75], v[44:47] cbsz:3 abid:5
  v_exp_f32 v60, v60
  v_exp_f32 v61, v61
  v_exp_f32 v62, v62
  v_exp_f32 v63, v63
  v_mfma_f32_4x4x4_16b_bf16 v[40:43], v[32:33], v[76:77], v[40:43] cbsz:3 abid:6
  v_mfma_f32_4x4x4_16b_bf16 v[44:47], v[32:33], v[78:79], v[44:47] cbsz:3 abid:7
  s_cmp_lt_u32 s37, 10
  s_cbranch_scc1 L_vw2
L_vr2:
  v_mfma_f32_4x4x4_16b_bf16 v[48:51], v[34:35], v[80:81], 0 cbsz:3 abid:0
  v_mfma_f32_4x4x4_16b_bf16 v[52:55], v[34:35], v[82:83], 0 cbsz:3 abid:1
  s_nop 0
  v_mfma_f32_4x4x4_16b_bf16 v[48:51], v[34:35], v[84:85], v[48:51] cbsz:3 abid:2
  v_mfma_f32_4x4x4_16b_bf16 v[52:55], v[34:35], v[86:87], v[52:55] cbsz:3 abid:3
  s_cmp_lt_u32 s37, 11
  s_cbranch_scc1 L_vw3
L_vr3:
  v_mfma_f32_4x4x4_16b_bf16 v[48:51], v[34:35], v[88:89], v[48:51] cbsz:3 abid:4
  v_mfma_f32_4x4x4_16b_bf16 v[52:55], v[34:35], v[90:91], v[52:55] cbsz:3 abid:5
  s_nop 0
  v_mfma_f32_4x4x4_16b_bf16 v[48:51], v[34:35], v[92:93], v[48:51] cbsz:3 abid:6
  v_mfma_f32_4x4x4_16b_bf16 v[52:55], v[34:35], v[94:95], v[52:55] cbsz:3 abid:7
  s_nop 0
  v_pk_add_f32 v[40:41], v[40:41], v[44:45]
  v_pk_add_f32 v[42:43], v[42:43], v[46:47]
  v_pk_mul_f32 v[40:41], v[40:41], v[56:57]
  v_pk_mul_f32 v[42:43], v[42:43], v[58:59]
  v_pk_add_f32 v[48:49], v[48:49], v[52:53]
  v_pk_add_f32 v[50:51], v[50:51], v[54:55]
  v_pk_fma_f32 v[40:41], v[48:49], v[60:61], v[40:41]
  v_pk_fma_f32 v[42:43], v[50:51], v[62:63], v[42:43]
  s_nop 0
  v_permlane32_swap_b32 v40, v41
  v_permlane32_swap_b32 v42, v43
  v_add_f32 v40, v40, v41
  v_add_f32 v42, v42, v43
  v_bfi_b32 v40, v125, v122, v40
  v_bfi_b32 v42, v125, v122, v42
  s_cmp_eq_u32 s41, 0
  s_cbranch_scc1 slow_132
  buffer_store_dword v40, v115, s[48:51], 0 offen
  buffer_store_dword v42, v115, s[48:51], s55 offen
st_133:
  s_cmp_ge_u32 s33, 28
  s_cselect_b32 s36, 18, 17
  s_mov_b32 s37, 65536
  v_mov_b32 v101, s32
  v_mov_b32 v103, s32
  s_mov_b32 s40, 65536
spin_140:
  ds_read_b32 v20, v1 offset:0
  s_sub_u32 s40, s40, 1
  s_cbranch_scc1 L_end
  s_waitcnt lgkmcnt(0)
  v_cmp_gt_u32 vcc, s36, v20
  s_cbranch_vccnz spin_140
  s_mov_b32 s40, 65536
  s_setprio 2
  s_mov_b32 exec_hi, 0
  buffer_load_dwordx4 v[32:35], v118, s[48:51], 0 offen sc1
  s_mov_b32 exec_hi, -1
  ds_read_b64_tr_b16 v[80:81], v14 offset:0
  ds_read_b64_tr_b16 v[82:83], v14 offset:2048
  ds_read_b64_tr_b16 v[84:85], v14 offset:4096
  ds_read_b64_tr_b16 v[86:87], v14 offset:6144
  ds_read_b64_tr_b16 v[88:89], v14 offset:8192
  ds_read_b64_tr_b16 v[90:91], v14 offset:10240
  buffer_load_dwordx4 v[64:67], v117, s[48:51], 0 offen sc1
  ds_read_b64_tr_b16 v[92:93], v14 offset:12288
  buffer_load_dwordx4 v[68:71], v117, s[48:51], s52 offen sc1
  ds_read_b64_tr_b16 v[94:95], v14 offset:14336
  buffer_load_dwordx4 v[72:75], v117, s[48:51], s53 offen sc1
  buffer_load_dwordx4 v[76:79], v117, s[48:51], s54 offen sc1
  s_waitcnt vmcnt(4)
h2w_138:
  v_max_f32_dpp v21, v32, v32 row_ror:1 row_mask:0xf bank_mask:0xf
  v_xor_b32 v20, s32, v33
  v_bitop3_b32 v20, v20, v35, s32 bitop3:0xf6
  v_max_f32_dpp v21, v21, v21 row_ror:2 row_mask:0xf bank_mask:0xf
  v_cmp_ne_u32 vcc, 0, v20
  ds_read_b32 v29, v1 offset:0
  v_max_f32_dpp v21, v21, v21 row_ror:4 row_mask:0xf bank_mask:0xf
  s_cmp_lg_u32 vcc_lo, 0
  s_cbranch_scc1 h2m_137
  v_max_f32_dpp v21, v21, v21 row_ror:8 row_mask:0xf bank_mask:0xf
  v_mov_b32 v22, v21
  ds_read_b64_tr_b16 v[48:49], v14 offset:16384
  ds_read_b64_tr_b16 v[50:51], v14 offset:18432
  v_permlane16_swap_b32 v21, v22
  v_max_f32 v21, v21, v22
  v_sub_f32 v32, v32, v21
  v_exp_f32 v32, v32
  ds_read_b64_tr_b16 v[52:53], v14 offset:20480
  v_mul_f32 v22, v32, v34
  ds_bpermute_b32 v36, v123, v32 offset:0
  ds_bpermute_b32 v37, v123, v32 offset:32
  ds_bpermute_b32 v38, v123, v32 offset:64
  ds_bpermute_b32 v39, v123, v32 offset:96
  ds_read_b64_tr_b16 v[54:55], v14 offset:22528
  ds_read_b32 v31, v18 offset:64
  s_waitcnt vmcnt(3)
  v_xor_b32 v64, s56, v64
  v_xor_b32 v65, s57, v65
  v_add_f32_dpp v22, v22, v22 row_ror:1 row_mask:0xf bank_mask:0xf
  v_xor_b32 v66, s58, v66
  v_xor_b32 v67, s59, v67
  v_add_f32_dpp v22, v22, v22 row_ror:2 row_mask:0xf bank_mask:0xf
  v_or_b32 v28, v64, v65
  v_or3_b32 v28, v28, v66, v67
  v_add_f32_dpp v22, v22, v22 row_ror:4 row_mask:0xf bank_mask:0xf
  s_waitcnt vmcnt(2)
  v_xor_b32 v68, s56, v68
  v_xor_b32 v69, s57, v69
  v_add_f32_dpp v22, v22, v22 row_ror:8 row_mask:0xf bank_mask:0xf
  v_mov_b32 v23, v22
  v_xor_b32 v70, s58, v70
  v_xor_b32 v71, s59, v71
  v_permlane16_swap_b32 v22, v23
  v_add_f32 v22, v22, v23
  v_rcp_f32 v22, v22
  v_or3_b32 v28, v28, v68, v69
  v_or3_b32 v28, v28, v70, v71
  s_waitcnt lgkmcnt(2)
  v_pk_mul_f32 v[24:25], v[64:65], v[36:37] op_sel:[0,0] op_sel_hi:[1,0]
  v_pk_mul_f32 v[26:27], v[66:67], v[36:37] op_sel:[0,0] op_sel_hi:[1,0]
  v_pk_fma_f32 v[24:25], v[68:69], v[36:37], v[24:25] op_sel:[0,1,0] op_sel_hi:[1,1,1]
  v_pk_fma_f32 v[26:27], v[70:71], v[36:37], v[26:27] op_sel:[0,1,0] op_sel_hi:[1,1,1]
  v_readfirstlane_b32 s35, v22
  s_waitcnt vmcnt(1)
  v_xor_b32 v72, s56, v72
  v_xor_b32 v73, s57, v73
  v_xor_b32 v74, s58, v74
  v_xor_b32 v75, s59, v75
  v_or3_b32 v28, v28, v72, v73
  v_or3_b32 v28, v28, v74, v75
  v_pk_fma_f32 v[24:25], v[72:73], v[38:39], v[24:25] op_sel:[0,0,0] op_sel_hi:[1,0,1]
  v_pk_fma_f32 v[26:27], v[74:75], v[38:39], v[26:27] op_sel:[0,0,0] op_sel_hi:[1,0,1]
  s_waitcnt vmcnt(0)
  v_xor_b32 v76, s56, v76
  v_xor_b32 v77, s57, v77
  v_xor_b32 v78, s58, v78
  v_xor_b32 v79, s59, v79
  v_or3_b32 v28, v28, v76, v77
  v_or3_b32 v28, v28, v78, v79
  v_pk_fma_f32 v[24:25], v[76:77], v[38:39], v[24:25] op_sel:[0,1,0] op_sel_hi:[1,1,1]
  v_cmp_ne_u32_sdwa vcc, v28, 0 src0_sel:BYTE_0 src1_sel:DWORD
  v_pk_fma_f32 v[26:27], v[78:79], v[38:39], v[26:27] op_sel:[0,1,0] op_sel_hi:[1,1,1]
  s_cbranch_vccnz h2g_135
h2d_136:
  v_permlane32_swap_b32 v24, v25
  v_permlane32_swap_b32 v26, v27
  s_waitcnt lgkmcnt(0)
  v_add_f32 v24, v24, v25
  v_add_f32 v26, v26, v27
  v_cmp_gt_u32 s[62:63], 18, v29
  v_readfirstlane_b32 s43, v31
  v_permlane16_swap_b32 v24, v26
  v_add_f32 v24, v24, v26
  s_cmp_eq_u32 s43, 0
  s_cselect_b64 s[62:63], -1, s[62:63]
  v_add_f32_dpp v24, v24, v24 row_ror:8 row_mask:0xf bank_mask:0xf
  v_mul_f32 v24, s35, v24
  v_cvt_pk_bf16_f32 v24, v24, v24
  ds_write_b16 v119, v24
  s_waitcnt lgkmcnt(0)
  s_barrier
  ds_read_b128 v[128:131], v120 offset:0
  ds_read_b128 v[132:135], v120 offset:64
  ds_read_b128 v[136:139], v120 offset:128
  ds_read_b128 v[140:143], v120 offset:192
  ds_read_b128 v[56:59], v120 offset:256
  ds_read_b128 v[60:63], v120 offset:320
  s_cmp_lg_u64 s[62:63], 0
  s_cbranch_scc1 L_rw
L_rr:
  s_waitcnt lgkmcnt(5)
  v_mfma_f32_16x16x32_bf16 v[96:99], v[128:131], v[80:83], 0
  s_waitcnt lgkmcnt(4)
  v_mfma_f32_16x16x32_bf16 v[96:99], v[132:135], v[84:87], v[96:99]
  s_waitcnt lgkmcnt(3)
  v_mfma_f32_16x16x32_bf16 v[96:99], v[136:139], v[88:91], v[96:99]
  s_waitcnt lgkmcnt(2)
  v_mfma_f32_16x16x32_bf16 v[96:99], v[140:143], v[92:95], v[96:99]
  s_cmp_ge_u32 s33, 28
  s_cbranch_scc1 L_mmd
  s_waitcnt lgkmcnt(0)
  v_mfma_f32_16x16x32_bf16 v[96:99], v[56:59], v[48:51], v[96:99]
  v_mfma_f32_16x16x32_bf16 v[96:99], v[60:63], v[52:55], v[96:99]
L_mmd:
  s_mov_b64 exec, 0xffff
  s_nop 6
  v_bfi_b32 v96, v125, v122, v96
  buffer_store_dword v96, v121, s[48:51], s43 offen sc1
  s_mov_b64 exec, -1
  s_cmp_ge_u32 s33, 28
  s_cbranch_scc0 L_cdone
  s_cmp_ge_u32 s33, 30
  s_cbranch_scc1 L_cdone
  s_cmp_lt_u32 s34, 2
  s_cbranch_scc0 L_cdone
  s_sub_u32 s38, s33, 28
  s_mul_i32 s38, s38, 2
  s_lshl2_add_u32 s38, s6, s38
  s_add_u32 s38, s38, s34
  ds_read_b32 v31, v1 offset:12
  s_mov_b32 s37, s38
  s_and_b32 s35, s37, 0
  s_andn2_b32 s37, s37, 0
  s_lshl1_add_u32 s35, s37, s35
  s_lshl_b32 s35, s35, 13
  s_add_u32 s35, s35, 286720
  v_lshrrev_b32 v24, 2, v0
  v_lshlrev_b32 v24, 8, v24
  v_and_b32 v25, 3, v0
  v_lshl_add_u32 v24, v25, 4, v24
  v_add_u32 v24, s35, v24
  v_add_u32 v23, 4096, v24
  v_and_b32 v25, 3, v0
  v_bfe_u32 v26, v0, 4, 1
  v_lshl_add_u32 v25, v25, 1, v26
  v_lshrrev_b32 v26, 5, v0
  v_lshl_add_u32 v25, v25, 1, v26
  s_lshl_b32 s35, s38, 5
  v_lshl_add_u32 v25, v25, 1, s35
  s_mov_b32 s44, s8
  s_and_b32 s45, s9, 0xffff
  s_mov_b32 s46, 1024
  s_mov_b32 s47, 0x20000
  s_mov_b32 s52, s26
  s_and_b32 s53, s27, 0xffff
  s_mov_b32 s54, 1024
  s_mov_b32 s55, 0x20000
  buffer_load_ushort v26, v25, s[44:47], 0 offen
  s_waitcnt lgkmcnt(0)
  v_readfirstlane_b32 s43, v31
  s_mov_b32 s40, 65536
  s_nop 3
  buffer_load_dwordx4 v[32:35], v24, s[48:51], s43 offen sc1
  buffer_load_dwordx4 v[36:39], v23, s[48:51], s43 offen sc1
  s_sleep 3
  buffer_load_dwordx4 v[48:51], v24, s[48:51], s43 offen sc1
  buffer_load_dwordx4 v[52:55], v23, s[48:51], s43 offen sc1
  s_sleep 3
  buffer_load_dwordx4 v[64:67], v24, s[48:51], s43 offen sc1
  buffer_load_dwordx4 v[68:71], v23, s[48:51], s43 offen sc1
  s_sleep 3
  buffer_load_dwordx4 v[80:83], v24, s[48:51], s43 offen sc1
  buffer_load_dwordx4 v[84:87], v23, s[48:51], s43 offen sc1
  s_cmp_eq_u32 s40, s40
  s_branch h3d_142
L_h3b:
  s_mov_b64 exec, -1
  s_cmp_lg_u32 s40, s40
h3_141:
  s_waitcnt vmcnt(6)
  v_xor_b32 v32, s56, v32
  v_xor_b32 v33, s57, v33
  v_xor_b32 v34, s58, v34
  v_xor_b32 v35, s59, v35
  v_xor_b32 v36, s56, v36
  v_xor_b32 v37, s57, v37
  v_xor_b32 v38, s58, v38
  v_xor_b32 v39, s59, v39
  v_or_b32 v20, v32, v33
  v_or3_b32 v20, v20, v34, v35
  v_or3_b32 v20, v20, v36, v37
  v_or3_b32 v20, v20, v38, v39
  v_pk_add_f32 v[28:29], v[32:33], v[36:37]
  v_cmp_ne_u32_sdwa vcc, v20, 0 src0_sel:BYTE_0 src1_sel:DWORD
  v_pk_add_f32 v[30:31], v[34:35], v[38:39]
  s_cbranch_vccz h3d_142
  buffer_load_dwordx4 v[32:35], v24, s[48:51], s43 offen sc1
  buffer_load_dwordx4 v[36:39], v23, s[48:51], s43 offen sc1
  s_waitcnt vmcnt(6)
  v_xor_b32 v48, s56, v48
  v_xor_b32 v49, s57, v49
  v_xor_b32 v50, s58, v50
  v_xor_b32 v51, s59, v51
  v_xor_b32 v52, s56, v52
  v_xor_b32 v53, s57, v53
  v_xor_b32 v54, s58, v54
  v_xor_b32 v55, s59, v55
  v_or_b32 v20, v48, v49
  v_or3_b32 v20, v20, v50, v51
  v_or3_b32 v20, v20, v52, v53
  v_or3_b32 v20, v20, v54, v55
  v_pk_add_f32 v[28:29], v[48:49], v[52:53]
  v_cmp_ne_u32_sdwa vcc, v20, 0 src0_sel:BYTE_0 src1_sel:DWORD
  v_pk_add_f32 v[30:31], v[50:51], v[54:55]
  s_cbranch_vccz h3d_142
  buffer_load_dwordx4 v[48:51], v24, s[48:51], s43 offen sc1
  buffer_load_dwordx4 v[52:55], v23, s[48:51], s43 offen sc1
  s_waitcnt vmcnt(6)
  v_xor_b32 v64, s56, v64
  v_xor_b32 v65, s57, v65
  v_xor_b32 v66, s58, v66
  v_xor_b32 v67, s59, v67
  v_xor_b32 v68, s56, v68
  v_xor_b32 v69, s57, v69
  v_xor_b32 v70, s58, v70
  v_xor_b32 v71, s59, v71
  v_or_b32 v20, v64, v65
  v_or3_b32 v20, v20, v66, v67
  v_or3_b32 v20, v20, v68, v69
  v_or3_b32 v20, v20, v70, v71
  v_pk_add_f32 v[28:29], v[64:65], v[68:69]
  v_cmp_ne_u32_sdwa vcc, v20, 0 src0_sel:BYTE_0 src1_sel:DWORD
  v_pk_add_f32 v[30:31], v[66:67], v[70:71]
  s_cbranch_vccz h3d_142
  buffer_load_dwordx4 v[64:67], v24, s[48:51], s43 offen sc1
  buffer_load_dwordx4 v[68:71], v23, s[48:51], s43 offen sc1
  s_waitcnt vmcnt(6)
  v_xor_b32 v80, s56, v80
  v_xor_b32 v81, s57, v81
  v_xor_b32 v82, s58, v82
  v_xor_b32 v83, s59, v83
  v_xor_b32 v84, s56, v84
  v_xor_b32 v85, s57, v85
  v_xor_b32 v86, s58, v86
  v_xor_b32 v87, s59, v87
  v_or_b32 v20, v80, v81
  v_or3_b32 v20, v20, v82, v83
  v_or3_b32 v20, v20, v84, v85
  v_or3_b32 v20, v20, v86, v87
  v_pk_add_f32 v[28:29], v[80:81], v[84:85]
  v_cmp_ne_u32_sdwa vcc, v20, 0 src0_sel:BYTE_0 src1_sel:DWORD
  v_pk_add_f32 v[30:31], v[82:83], v[86:87]
  s_cbranch_vccz h3d_142
  buffer_load_dwordx4 v[80:83], v24, s[48:51], s43 offen sc1
  buffer_load_dwordx4 v[84:87], v23, s[48:51], s43 offen sc1
  s_sub_u32 s40, s40, 1
  s_cbranch_scc0 h3_141
  s_branch L_end
h3d_142:
  v_permlane32_swap_b32 v28, v29
  v_permlane32_swap_b32 v30, v31
  v_lshlrev_b32 v27, 16, v26
  v_add_f32 v28, v28, v29
  v_add_f32 v30, v30, v31
  s_nop 1
  v_permlane16_swap_b32 v28, v30
  v_add_f32 v28, v28, v30
  s_nop 1
  v_add_f32_dpp v28, v28, v28 row_ror:4 row_mask:0xf bank_mask:0xf
  s_mov_b32 s36, 0x000f000f
  s_nop 0
  v_add_f32_dpp v28, v28, v28 row_ror:8 row_mask:0xf bank_mask:0xf
  s_mov_b32 exec_lo, s36
  s_mov_b32 exec_hi, s36
  v_add_f32 v28, v28, v27
  v_cvt_pk_bf16_f32 v28, v28, v28
  s_cbranch_scc1 L_h3b
  buffer_store_short v28, v25, s[52:55], 0 offen
  s_cmp_eq_u32 s38, 0
  s_cbranch_scc0 L_cdone
  s_mov_b64 exec, 1
  v_mov_b32 v25, s32
  buffer_store_dword v25, off, s[48:51], 0
L_cdone:
  s_endpgm
L_vc1a:
  s_waitcnt vmcnt(0)
  s_mov_b64 exec, 1
  buffer_load_dwordx4 v[44:47], off, s[48:51], s33 offset:3072 sc1
  s_mov_b64 exec, -1
  s_sub_u32 s40, s40, 1
  s_cbranch_scc1 L_end
  s_waitcnt vmcnt(0)
  s_branch L_vc0a
L_dec:
  s_cmp_ge_u32 s33, 30
  s_cbranch_scc1 L_dec2
  v_lshlrev_b32 v41, 2, v0
  buffer_load_dword v44, v41, s[48:51], 0 offen offset:2048 sc1
  s_sub_u32 s35, s33, 28
  s_mul_i32 s35, s35, 2
  s_lshl2_add_u32 s35, s6, s35
  s_lshl_b32 s35, s35, 2
  s_waitcnt vmcnt(0)
  v_xor_b32 v41, s32, v44
  v_cmp_eq_u32 vcc, 1, v41
  s_nop 0
  s_bcnt1_i32_b64 s36, vcc
  v_cmp_eq_u32 vcc, 2, v41
  s_nop 0
  s_bcnt1_i32_b64 s37, vcc
  s_cmp_gt_u32 s37, s36
  s_cselect_b32 s38, 0, 1
  s_getreg_b32 s39, hwreg(HW_REG_XCC_ID, 2, 1)
  s_xor_b32 s39, s39, s38
  s_xor_b32 s38, s39, s32
  s_lshl_b32 s39, 0x2000, s39
  v_mov_b32 v41, s39
  v_mov_b32 v42, s38
  ds_write_b32 v1, v41 offset:12
  v_lshlrev_b32 v43, 2, v0
  s_mov_b64 exec, 3
  buffer_store_dword v42, v43, s[48:51], s35 offen offset:3072 sc1
  s_mov_b64 exec, -1
L_dec2:
  s_not_b32 s37, s32
  v_mov_b32 v44, s37
  s_lshl_b32 s33, s6, 4
  s_mov_b32 s40, 65536
spin_108:
  s_sleep 4
  ds_read_b32 v28, v1 offset:0
  s_sub_u32 s40, s40, 1
  s_cbranch_scc1 L_end
  s_waitcnt lgkmcnt(0)
  v_cmp_gt_u32 vcc, 11, v28
  s_cbranch_vccnz spin_108
  s_mov_b64 exec, 1
  buffer_load_dwordx4 v[44:47], off, s[48:51], s33 offset:3072 sc1
  s_mov_b64 exec, -1
  s_mov_b32 s40, 65536
  s_waitcnt vmcnt(0)
L_vc0a:
  s_mov_b64 exec, 1
  v_xor_b32 v44, s32, v44
  v_xor_b32 v45, s32, v45
  v_xor_b32 v46, s32, v46
  v_xor_b32 v47, s32, v47
  s_movk_i32 s39, 0x2000
  v_or_b32 v41, v44, v45
  v_or3_b32 v41, v41, v46, v47
  v_cmp_lt_u32 vcc, 1, v41
  v_lshlrev_b32 v44, v44, s39
  v_lshlrev_b32 v45, v45, s39
  v_lshlrev_b32 v46, v46, s39
  v_lshlrev_b32 v47, v47, s39
  s_cbranch_vccnz L_vc1a
  ds_write_b128 v1, v[44:47] offset:64
  s_mov_b64 exec, -1
  s_branch L_adone
slow_115:
  s_nop 1
  buffer_store_dwordx4 v[48:51], v9, s[48:51], 0 offen sc1
  s_nop 1
  s_branch st_116
L_vc1b:
  s_waitcnt vmcnt(0)
  s_mov_b64 exec, 1
  buffer_load_dwordx4 v[44:47], off, s[48:51], s33 offset:3072 sc1
  s_mov_b64 exec, -1
  s_sub_u32 s40, s40, 1
  s_cbranch_scc1 L_end
  s_waitcnt vmcnt(0)
  s_branch L_vc0b
L_h1sw:
  s_cmp_eq_u32 s39, 8
  s_cbranch_scc0 L_h1t
  s_mov_b32 s40, 65536
spin_122:
  ds_read_b32 v20, v1 offset:8
  s_sub_u32 s40, s40, 1
  s_cbranch_scc1 L_end
  s_waitcnt lgkmcnt(0)
  v_cmp_gt_u32 vcc, 1, v20
  s_cbranch_vccnz spin_122
  v_lshlrev_b32 v20, 4, v0
  v_add_u32 v21, 128768, v20
  s_mov_b64 exec, 0xffff
  ds_read_b128 v[96:99], v21
  s_lshl_b32 s35, s4, 5
  s_lshl2_add_u32 s35, s6, s35
  s_add_u32 s35, s35, s7
  s_lshl_b32 s35, s35, 8
  s_add_u32 s35, s35, 69632
  s_and_b32 s56, s32, 0xff
  s_bfe_u32 s57, s32, 0x80008
  s_bfe_u32 s58, s32, 0x80010
  s_lshr_b32 s59, s32, 24
  s_waitcnt lgkmcnt(0)
  v_bfi_b32 v96, v125, s56, v96
  v_bfi_b32 v97, v125, s57, v97
  v_bfi_b32 v98, v125, s58, v98
  v_bfi_b32 v99, v125, s59, v99
  buffer_store_dwordx4 v[96:99], v20, s[48:51], s35 offen sc1
  s_waitcnt vmcnt(0)
  s_mov_b64 exec, -1
L_h1t:
  s_xor_b32 s43, s43, 65536
  s_cselect_b32 s35, s32, s42
  s_cselect_b32 s41, 1, 3
  s_and_b32 s56, s35, 0xff
  s_bfe_u32 s57, s35, 0x80008
  s_bfe_u32 s58, s35, 0x80010
  s_lshr_b32 s59, s35, 24
  s_branch h1k_121
slow_126:
  s_nop 1
  buffer_store_dwordx4 v[146:149], v116, s[48:51], 0 offen sc1
  s_nop 1
  s_branch st_127
L_vw0:
  s_mov_b32 s40, 65536
spin_128:
  ds_read_b32 v20, v1 offset:0
  ds_read_b64_tr_b16 v[64:65], v12 offset:0
  ds_read_b64_tr_b16 v[66:67], v12 offset:2048
  ds_read_b64_tr_b16 v[68:69], v12 offset:4096
  ds_read_b64_tr_b16 v[70:71], v12 offset:6144
  s_sub_u32 s40, s40, 1
  s_cbranch_scc1 L_end
  s_waitcnt lgkmcnt(0)
  v_cmp_gt_u32 vcc, 8, v20
  s_cbranch_vccnz spin_128
  s_branch L_vr0
L_vw1:
  s_mov_b32 s40, 65536
spin_129:
  ds_read_b32 v20, v1 offset:0
  ds_read_b64_tr_b16 v[72:73], v12 offset:8192
  ds_read_b64_tr_b16 v[74:75], v12 offset:10240
  ds_read_b64_tr_b16 v[76:77], v12 offset:12288
  ds_read_b64_tr_b16 v[78:79], v12 offset:14336
  s_sub_u32 s40, s40, 1
  s_cbranch_scc1 L_end
  s_waitcnt lgkmcnt(0)
  v_cmp_gt_u32 vcc, 9, v20
  s_cbranch_vccnz spin_129
  s_branch L_vr1
L_vw2:
  s_mov_b32 s40, 65536
spin_130:
  ds_read_b32 v20, v1 offset:0
  ds_read_b64_tr_b16 v[80:81], v12 offset:16384
  ds_read_b64_tr_b16 v[82:83], v12 offset:18432
  ds_read_b64_tr_b16 v[84:85], v12 offset:20480
  ds_read_b64_tr_b16 v[86:87], v12 offset:22528
  s_sub_u32 s40, s40, 1
  s_cbranch_scc1 L_end
  s_waitcnt lgkmcnt(0)
  v_cmp_gt_u32 vcc, 10, v20
  s_cbranch_vccnz spin_130
  s_branch L_vr2
L_vw3:
  s_mov_b32 s40, 65536
spin_131:
  ds_read_b32 v20, v1 offset:0
  ds_read_b64_tr_b16 v[88:89], v12 offset:24576
  ds_read_b64_tr_b16 v[90:91], v12 offset:26624
  ds_read_b64_tr_b16 v[92:93], v12 offset:28672
  ds_read_b64_tr_b16 v[94:95], v12 offset:30720
  s_sub_u32 s40, s40, 1
  s_cbranch_scc1 L_end
  s_waitcnt lgkmcnt(0)
  v_cmp_gt_u32 vcc, 11, v20
  s_cbranch_vccnz spin_131
  s_branch L_vr3
slow_132:
  s_nop 1
  buffer_store_dword v40, v115, s[48:51], 0 offen sc1
  buffer_store_dword v42, v115, s[48:51], s55 offen sc1
  s_nop 1
  s_branch st_133
h2m_137:
  s_mov_b32 exec_hi, 0
  buffer_load_dwordx4 v[32:35], v118, s[48:51], 0 offen sc1
  s_mov_b32 exec_hi, -1
  s_sub_u32 s37, s37, 1
  s_cbranch_scc1 L_end
  s_waitcnt vmcnt(0)
  s_mov_b32 exec_hi, 0
  v_xor_b32 v20, s32, v33
  v_bitop3_b32 v20, v20, v35, s32 bitop3:0xf6
  v_cmp_ne_u32 vcc, 0, v20
  s_mov_b32 exec_hi, -1
  s_cbranch_vccnz h2m_137
  s_branch h2w_138
h2g_135:
  s_mov_b64 exec, vcc
  buffer_load_dwordx4 v[64:67], v117, s[48:51], 0 offen sc1
  buffer_load_dwordx4 v[68:71], v117, s[48:51], s52 offen sc1
  buffer_load_dwordx4 v[72:75], v117, s[48:51], s53 offen sc1
  buffer_load_dwordx4 v[76:79], v117, s[48:51], s54 offen sc1
  s_sub_u32 s37, s37, 1
  s_cbranch_scc1 L_end
  s_waitcnt vmcnt(3)
  v_xor_b32 v64, s56, v64
  v_xor_b32 v65, s57, v65
  v_xor_b32 v66, s58, v66
  v_xor_b32 v67, s59, v67
  v_or_b32 v28, v64, v65
  v_or3_b32 v28, v28, v66, v67
  s_waitcnt vmcnt(2)
  v_xor_b32 v68, s56, v68
  v_xor_b32 v69, s57, v69
  v_xor_b32 v70, s58, v70
  v_xor_b32 v71, s59, v71
  v_or3_b32 v28, v28, v68, v69
  v_or3_b32 v28, v28, v70, v71
  s_waitcnt vmcnt(1)
  v_xor_b32 v72, s56, v72
  v_xor_b32 v73, s57, v73
  v_xor_b32 v74, s58, v74
  v_xor_b32 v75, s59, v75
  v_or3_b32 v28, v28, v72, v73
  v_or3_b32 v28, v28, v74, v75
  s_waitcnt vmcnt(0)
  v_xor_b32 v76, s56, v76
  v_xor_b32 v77, s57, v77
  v_xor_b32 v78, s58, v78
  v_xor_b32 v79, s59, v79
  v_or3_b32 v28, v28, v76, v77
  v_or3_b32 v28, v28, v78, v79
  v_cmp_ne_u32_sdwa vcc, v28, 0 src0_sel:BYTE_0 src1_sel:DWORD
  s_cbranch_vccnz h2g_135
  s_mov_b64 exec, -1
  v_pk_mul_f32 v[24:25], v[64:65], v[36:37] op_sel:[0,0] op_sel_hi:[1,0]
  v_pk_mul_f32 v[26:27], v[66:67], v[36:37] op_sel:[0,0] op_sel_hi:[1,0]
  v_pk_fma_f32 v[24:25], v[68:69], v[36:37], v[24:25] op_sel:[0,1,0] op_sel_hi:[1,1,1]
  v_pk_fma_f32 v[26:27], v[70:71], v[36:37], v[26:27] op_sel:[0,1,0] op_sel_hi:[1,1,1]
  v_pk_fma_f32 v[24:25], v[72:73], v[38:39], v[24:25] op_sel:[0,0,0] op_sel_hi:[1,0,1]
  v_pk_fma_f32 v[26:27], v[74:75], v[38:39], v[26:27] op_sel:[0,0,0] op_sel_hi:[1,0,1]
  v_pk_fma_f32 v[24:25], v[76:77], v[38:39], v[24:25] op_sel:[0,1,0] op_sel_hi:[1,1,1]
  v_pk_fma_f32 v[26:27], v[78:79], v[38:39], v[26:27] op_sel:[0,1,0] op_sel_hi:[1,1,1]
  s_nop 1
  s_branch h2d_136
L_rw:
  ds_read_b32 v31, v18 offset:64
  ds_read_b64_tr_b16 v[48:49], v14 offset:16384
  ds_read_b64_tr_b16 v[50:51], v14 offset:18432
  ds_read_b64_tr_b16 v[52:53], v14 offset:20480
  ds_read_b64_tr_b16 v[54:55], v14 offset:22528
  s_waitcnt lgkmcnt(0)
  v_readfirstlane_b32 s43, v31
  s_branch L_rr
L_end:
  s_endpgm
.section .rodata,"a"
.p2align 6
.amdhsa_kernel parallel_sum__sliding_block_cached__swiglu_ffn__decode_kernel
  .amdhsa_next_free_vgpr 184
  .amdhsa_next_free_sgpr 102
  .amdhsa_accum_offset 184
  .amdhsa_group_segment_fixed_size 0
  .amdhsa_kernarg_size 96
  .amdhsa_user_sgpr_count 2
  .amdhsa_user_sgpr_kernarg_segment_ptr 1
  .amdhsa_system_sgpr_workgroup_id_x 1
  .amdhsa_float_denorm_mode_32 3
.end_amdhsa_kernel
```
